```python
import torch

def _softmax(x, axis=-1):
    return torch.softmax(x, dim=axis)

def _gelu(x):
    return torch.nn.functional.gelu(x, approximate='tanh')

def _silu(x):
    return torch.nn.functional.silu(x)

def _sigmoid(x):
    return torch.sigmoid(x)

def _layernorm(x, axis=-1, eps=1e-05):
    m = x.mean(dim=axis, keepdim=True)
    v = x.var(dim=axis, keepdim=True, unbiased=False)
    return (x - m) / torch.sqrt(v + eps)

def _scatter_add(tgt, idx, src, axis=0):
    return tgt.clone().index_add_(axis, idx, src)

def _segment_sum(src, seg, n):
    out = torch.zeros((n,) + src.shape[1:], dtype=src.dtype)
    return out.index_add_(0, seg, src)

def _pad(x, pw):
    flat = tuple((v for pair in reversed(pw) for v in pair))
    return torch.nn.functional.pad(x, flat)
kernel_name = 'adaLN_cond__sliding_block_cached__geglu_ffn__decode'

def setup_inputs():

    _w = lambda a: (lambda t: t.to(torch.bfloat16) if t.is_floating_point() else t)(torch.as_tensor(a))

    def _A_setup():
        B, Sq, D = (1, 1, 640)
        Hq, Hkv, Sk, Dh = (32, 32, 16384, 128)
        assert Hq % Hkv == 0, (Hq, Hkv)
        return {'x': _w((lambda *s: torch.randn(*s, dtype=torch.bfloat16) * 0.1)(B, Sq, D)), 'k_cache': _w((lambda *s: torch.randn(*s, dtype=torch.bfloat16) * 0.8)(B, Hkv, Sk, Dh)), 'v_cache': _w((lambda *s: torch.randn(*s, dtype=torch.bfloat16) * 0.8)(B, Hkv, Sk, Dh)), 'wq': _w((lambda *s: torch.randn(*s, dtype=torch.bfloat16) * 0.8)(D, Hq * Dh) * D ** (-0.5)), 'wo': _w((lambda *s: torch.randn(*s, dtype=torch.bfloat16) * 0.8)(Hq * Dh, D) * (Hq * Dh) ** (-0.5))}
    _A_in = _A_setup()

    def _B_setup():
        B, S, D, F = (1, 1, 640, 1728)
        return {'x': _w((lambda *s: torch.randn(*s, dtype=torch.bfloat16) * 0.1)(B, S, D)), 'w_gate': _w((lambda *s: torch.randn(*s, dtype=torch.bfloat16) * 0.1)(D, F)), 'w_up': _w((lambda *s: torch.randn(*s, dtype=torch.bfloat16) * 0.1)(D, F)), 'w_down': _w((lambda *s: torch.randn(*s, dtype=torch.bfloat16) * 0.1)(F, D))}
    _B_in = _B_setup()
    return {'A_x': _A_in['x'], 'A_k_cache': _A_in['k_cache'], 'A_v_cache': _A_in['v_cache'], 'A_wq': _A_in['wq'], 'A_wo': _A_in['wo'], 'B_x': _B_in['x'], 'B_w_gate': _B_in['w_gate'], 'B_w_up': _B_in['w_up'], 'B_w_down': _B_in['w_down'], 'c': _w((lambda *s: torch.randn(*s, dtype=torch.bfloat16) * 0.8)(1, 640) * 8.0), 'w_mod': _w((lambda *s: torch.randn(*s, dtype=torch.bfloat16) * 0.8)(640, 6 * 640) * 640 ** (-0.5) * 8.0)}

def reference(A_x, A_k_cache, A_v_cache, A_wq, A_wo, B_x, B_w_gate, B_w_up, B_w_down, c, w_mod):

    def _A_ref(x, k_cache, v_cache, wq, wo):
        B, Sq, D = x.shape
        Hq, Dh = (32, 128)
        Hkv, Sk = (k_cache.shape[1], k_cache.shape[2])
        W = min(4096, max(256, Sk // 4))
        rep = Hq // Hkv
        q = (lambda x, *d: x.permute(*d))((x @ wq).reshape(B, Sq, Hq, Dh), 0, 2, 1, 3)
        k = (lambda x, n, axis: torch.repeat_interleave(x, n, dim=axis))(k_cache[:, :, Sk - W:, :], rep, axis=1)
        v = (lambda x, n, axis: torch.repeat_interleave(x, n, dim=axis))(v_cache[:, :, Sk - W:, :], rep, axis=1)
        scores = torch.einsum('bhqd,bhkd->bhqk', q, k) * Dh ** (-0.5)
        p = _softmax(scores, axis=-1)
        o = torch.einsum('bhqk,bhkd->bhqd', p, v)
        return (lambda x, *d: x.permute(*d))(o, 0, 2, 1, 3).reshape(B, Sq, Hq * Dh) @ wo

    def _B_ref(x, w_gate, w_up, w_down):
        return _gelu(x @ w_gate) * (x @ w_up) @ w_down
    x = A_x
    mod = (_silu(c) @ w_mod).reshape(c.shape[0], 6, 1, -1)
    sa, ca, ga, sb, cb, gb = (mod[:, 0].clone(), mod[:, 1].clone(), mod[:, 2].clone(), mod[:, 3].clone(), mod[:, 4].clone(), mod[:, 5].clone())
    h = _layernorm(x, axis=-1) * (1 + ca) + sa
    x = x + ga * _A_ref(h, A_k_cache, A_v_cache, A_wq, A_wo)
    h = _layernorm(x, axis=-1) * (1 + cb) + sb
    x = x + gb * _B_ref(h, B_w_gate, B_w_up, B_w_down)
    return x
```

```asm
; @launch grid=(256,1,1) block=(768,1,1) lds=163840
.amdgcn_target "amdgcn-amd-amdhsa--gfx950"
.text
.globl adaLN_cond__sliding_block_cached__geglu_ffn__decode_kernel
.p2align 8
.type adaLN_cond__sliding_block_cached__geglu_ffn__decode_kernel,@function
adaLN_cond__sliding_block_cached__geglu_ffn__decode_kernel:
    s_load_dwordx16 s[4:19], s[0:1], 0
    s_load_dwordx8 s[20:27], s[0:1], 64
    s_load_dwordx4 s[28:31], s[0:1], 96
    s_cmp_ge_u32 s2, 256
    s_cbranch_scc1 L_end
    s_getpc_b64 s[70:71]
L_pc:
    v_sub_u32 v2, 767, v0
    v_lshlrev_b32 v2, 7, v2
    v_min_u32 v2, L_codeend-L_pc-4, v2
    global_load_dword v167, v2, s[70:71]
    v_lshrrev_b32 v2, 6, v0
    v_lshlrev_b32 v3, 4, v0
    v_mov_b64 v[6:7], 0
    v_mov_b64 v[8:9], 0
    v_readfirstlane_b32 s3, v2
    ds_write_b128 v3, v[6:9]
    v_and_b32 v0, 63, v0
    s_lshr_b32 s53, s2, 3
    s_add_u32 s54, s2, 7
    s_and_b32 s54, s54, 7
    s_mov_b32 s99, 0x100000
    s_cmp_eq_u32 s54, 7
    s_cbranch_scc1 L_tail
    s_cmp_ge_u32 s3, 2
    s_cbranch_scc1 L_kv
    s_setprio 3
    v_lshrrev_b32 v9, 3, v0
    v_and_b32 v10, 7, v0
    v_lshlrev_b32 v15, 4, v10
    s_cmp_lt_u32 s54, 4
    s_cbranch_scc1 L_fe2
    s_mul_i32 s72, s53, 3
    s_add_u32 s72, s72, s54
    s_sub_u32 s72, s72, 4
    s_cmp_ge_u32 s72, 80
    s_cbranch_scc1 L_idle
    s_and_b32 s64, s72, 3
    s_lshr_b32 s65, s72, 2
    s_mul_i32 s66, s64, 160
    s_mul_i32 s67, s3, 80
    s_add_u32 s66, s66, s67
    v_min_u32 v11, 4, v10
    v_mad_u32_u24 v11, v9, 5, v11
    v_lshlrev_b32 v11, 1, v11
    v_add_lshl_u32 v11, v11, s66, 1
    v_mov_b32 v16, 76800
    v_mad_u32_u24 v16, v9, v16, v15
    s_mul_i32 s68, s66, 7680
    s_lshl_b32 s69, s65, 7
    s_add_u32 s68, s68, s69
    s_waitcnt lgkmcnt(0)
    s_load_dword s52, s[30:31], 0
    global_load_dword v164, v11, s[22:23]
    s_mov_b32 s40, s24
    s_mov_b32 s41, s25
    s_mov_b32 s42, 4915200
    s_mov_b32 s43, 0x20000
    s_movk_i32 s69, 7680
    buffer_load_dwordx4 v[120:123], v16, s[40:43], s68 offen nt
    s_add_u32 s68, s68, s69
    buffer_load_dwordx4 v[124:127], v16, s[40:43], s68 offen nt
    s_add_u32 s68, s68, s69
    buffer_load_dwordx4 v[128:131], v16, s[40:43], s68 offen nt
    s_add_u32 s68, s68, s69
    buffer_load_dwordx4 v[132:135], v16, s[40:43], s68 offen nt
    s_add_u32 s68, s68, s69
    buffer_load_dwordx4 v[136:139], v16, s[40:43], s68 offen nt
    s_add_u32 s68, s68, s69
    buffer_load_dwordx4 v[140:143], v16, s[40:43], s68 offen nt
    s_add_u32 s68, s68, s69
    buffer_load_dwordx4 v[144:147], v16, s[40:43], s68 offen nt
    s_add_u32 s68, s68, s69
    buffer_load_dwordx4 v[148:151], v16, s[40:43], s68 offen nt
    s_add_u32 s68, s68, s69
    buffer_load_dwordx4 v[152:155], v16, s[40:43], s68 offen nt
    s_add_u32 s68, s68, s69
    buffer_load_dwordx4 v[156:159], v16, s[40:43], s68 offen nt
    s_barrier
    s_mul_i32 s83, s64, 10240
    s_lshl_b32 s70, s65, 9
    s_add_u32 s83, s83, s70
    s_add_u32 s83, s83, 4096
    s_and_b32 s64, s72, 1
    s_lshr_b32 s65, s72, 1
    s_mul_i32 s79, s64, 20480
    s_lshl_b32 s70, s65, 9
    s_add_u32 s79, s79, s70
    s_add_u32 s79, s79, 45056
    s_lshl1_add_u32 s66, s64, s3
    s_mul_i32 s66, s66, 160
    s_add_u32 s65, s65, 20
    s_mul_i32 s68, s66, 7680
    s_lshl_b32 s69, s65, 7
    s_add_u32 s68, s68, s69
    v_mul_u32_u24 v17, 7680, v9
    v_lshl_add_u32 v16, v17, 4, v15
    v_lshl_add_u32 v17, v17, 2, v15
    v_add_u32 v17, 860160, v17
    s_lshl_b32 s67, s66, 1
    v_lshl_add_u32 v11, v0, 2, s67
    v_lshrrev_b32 v14, 2, v0
    v_lshl_add_u32 v12, v14, 2, s67
    global_load_dword v160, v11, s[22:23]
    global_load_dword v161, v12, s[22:23] offset:256
    s_movk_i32 s64, 7680
    buffer_load_dwordx4 v[40:43], v16, s[40:43], s68 offen nt
    s_add_u32 s68, s68, s64
    buffer_load_dwordx4 v[44:47], v16, s[40:43], s68 offen nt
    s_add_u32 s68, s68, s64
    buffer_load_dwordx4 v[48:51], v16, s[40:43], s68 offen nt
    s_add_u32 s68, s68, s64
    buffer_load_dwordx4 v[52:55], v16, s[40:43], s68 offen nt
    s_add_u32 s68, s68, s64
    buffer_load_dwordx4 v[56:59], v16, s[40:43], s68 offen nt
    s_add_u32 s68, s68, s64
    buffer_load_dwordx4 v[60:63], v16, s[40:43], s68 offen nt
    s_add_u32 s68, s68, s64
    buffer_load_dwordx4 v[64:67], v16, s[40:43], s68 offen nt
    s_add_u32 s68, s68, s64
    buffer_load_dwordx4 v[68:71], v16, s[40:43], s68 offen nt
    s_add_u32 s68, s68, s64
    buffer_load_dwordx4 v[72:75], v16, s[40:43], s68 offen nt
    s_add_u32 s68, s68, s64
    buffer_load_dwordx4 v[76:79], v16, s[40:43], s68 offen nt
    s_add_u32 s68, s68, s64
    buffer_load_dwordx4 v[80:83], v16, s[40:43], s68 offen nt
    s_add_u32 s68, s68, s64
    buffer_load_dwordx4 v[84:87], v16, s[40:43], s68 offen nt
    s_add_u32 s68, s68, s64
    buffer_load_dwordx4 v[88:91], v16, s[40:43], s68 offen nt
    s_add_u32 s68, s68, s64
    buffer_load_dwordx4 v[92:95], v16, s[40:43], s68 offen nt
    s_add_u32 s68, s68, s64
    buffer_load_dwordx4 v[96:99], v16, s[40:43], s68 offen nt
    s_add_u32 s68, s68, s64
    buffer_load_dwordx4 v[100:103], v16, s[40:43], s68 offen nt
    s_add_u32 s68, s68, s64
    buffer_load_dwordx4 v[104:107], v17, s[40:43], s68 offen nt
    s_add_u32 s68, s68, s64
    buffer_load_dwordx4 v[108:111], v17, s[40:43], s68 offen nt
    s_add_u32 s68, s68, s64
    buffer_load_dwordx4 v[112:115], v17, s[40:43], s68 offen nt
    s_add_u32 s68, s68, s64
    buffer_load_dwordx4 v[116:119], v17, s[40:43], s68 offen nt
    s_mov_b32 s32, s30
    s_mov_b32 s33, s31
    s_mov_b32 s34, 660736
    s_mov_b32 s35, 0x20000
    v_and_b32 v8, 1, v0
    v_lshlrev_b32 v8, 4, v8
    v_lshlrev_b32_e64 v8, v8, 1
    v_bfe_u32 v7, v0, 1, 2
    v_cmp_eq_u32 vcc, 0, v7
    s_nop 1
    v_cndmask_b32 v2, 0, v8, vcc
    v_cmp_eq_u32 vcc, 1, v7
    s_nop 1
    v_cndmask_b32 v3, 0, v8, vcc
    v_cmp_eq_u32 vcc, 2, v7
    s_nop 1
    v_cndmask_b32 v4, 0, v8, vcc
    v_cmp_eq_u32 vcc, 3, v7
    s_nop 1
    v_cndmask_b32 v5, 0, v8, vcc
    v_bfe_u32 v7, v0, 4, 1
    v_lshlrev_b32 v7, 7, v7
    v_lshl_add_u32 v18, v10, 2, v7
    v_lshrrev_b32 v7, 5, v0
    v_lshl_add_u32 v18, v7, 5, v18
    s_lshl_b32 s96, s3, 8
    s_add_u32 s96, s96, 256
    v_add_u32 v18, s96, v18
    v_lshlrev_b32 v19, 2, v0
    v_lshlrev_b32 v13, 3, v0
    v_mov_b32 v8, 1
    s_waitcnt lgkmcnt(0)
    s_mul_i32 s52, s52, 0x5bd1e9c5
    s_add_u32 s52, s52, 0x6a09e6b7
    v_mov_b32 v39, s52
    s_waitcnt vmcnt(32)
    v_lshlrev_b32 v20, 16, v164
    v_and_b32 v21, 0xffff0000, v164
    v_max_f32 v24, 0xc2ae0000, v20
    v_sub_f32 v24, 0, v24
    v_max_f32 v25, 0xc2ae0000, v21
    v_sub_f32 v25, 0, v25
    v_mul_f32 v28, 0x3fb8aa3b, v24
    v_mul_f32 v29, 0x3fb8aa3b, v25
    s_mov_b32 s96, 0x3fb8aa3b
    s_mov_b32 s97, 0x32a57060
    v_fma_f32 v32, v24, s96, -v28
    v_fma_f32 v33, v25, s96, -v29
    v_fma_f32 v32, v24, s97, v32
    v_fma_f32 v33, v25, s97, v33
    v_exp_f32 v28, v28
    v_exp_f32 v29, v29
    v_mul_f32 v32, 0x3f317218, v32
    v_mul_f32 v33, 0x3f317218, v33
    v_fma_f32 v24, v28, v32, v28
    v_fma_f32 v25, v29, v33, v29
    v_add_f32 v24, 1.0, v24
    v_add_f32 v25, 1.0, v25
    v_rcp_f32 v28, v24
    v_rcp_f32 v29, v25
    v_fma_f32 v32, -v24, v28, 1.0
    v_fma_f32 v33, -v25, v29, 1.0
    v_fma_f32 v28, v32, v28, v28
    v_fma_f32 v29, v33, v29, v29
    v_mul_f32 v32, v20, v28
    v_mul_f32 v33, v21, v29
    v_fma_f32 v20, -v32, v24, v20
    v_fma_f32 v21, -v33, v25, v21
    v_fma_f32 v20, v20, v28, v32
    v_fma_f32 v21, v21, v29, v33
    v_cvt_pk_bf16_f32 v20, v20, v21
    s_nop 1
    v_mov_b32_dpp v22, v20 row_newbcast:0 row_mask:0xf bank_mask:0x3
    s_nop 1
    v_mov_b32_dpp v22, v20 row_newbcast:8 row_mask:0xf bank_mask:0xc
    v_mul_u32_u24_sdwa v26, v22, v2 dst_sel:DWORD dst_unused:UNUSED_PAD src0_sel:WORD_0 src1_sel:DWORD
    v_mul_u32_u24_sdwa v27, v22, v3 dst_sel:DWORD dst_unused:UNUSED_PAD src0_sel:WORD_0 src1_sel:DWORD
    v_mul_u32_u24_sdwa v28, v22, v4 dst_sel:DWORD dst_unused:UNUSED_PAD src0_sel:WORD_0 src1_sel:DWORD
    v_mul_u32_u24_sdwa v29, v22, v5 dst_sel:DWORD dst_unused:UNUSED_PAD src0_sel:WORD_0 src1_sel:DWORD
    v_mov_b32_dpp v23, v20 row_newbcast:1 row_mask:0xf bank_mask:0x3
    s_nop 1
    v_mov_b32_dpp v23, v20 row_newbcast:9 row_mask:0xf bank_mask:0xc
    v_mul_u32_u24_sdwa v30, v22, v2 dst_sel:DWORD dst_unused:UNUSED_PAD src0_sel:WORD_1 src1_sel:DWORD
    v_mul_u32_u24_sdwa v31, v22, v3 dst_sel:DWORD dst_unused:UNUSED_PAD src0_sel:WORD_1 src1_sel:DWORD
    v_mul_u32_u24_sdwa v32, v22, v4 dst_sel:DWORD dst_unused:UNUSED_PAD src0_sel:WORD_1 src1_sel:DWORD
    v_mul_u32_u24_sdwa v33, v22, v5 dst_sel:DWORD dst_unused:UNUSED_PAD src0_sel:WORD_1 src1_sel:DWORD
    s_waitcnt vmcnt(31)
    v_mfma_f32_16x16x32_bf16 v[34:37], v[120:123], v[26:29], 0
    v_mul_u32_u24_sdwa v26, v23, v2 dst_sel:DWORD dst_unused:UNUSED_PAD src0_sel:WORD_0 src1_sel:DWORD
    v_mul_u32_u24_sdwa v27, v23, v3 dst_sel:DWORD dst_unused:UNUSED_PAD src0_sel:WORD_0 src1_sel:DWORD
    v_mul_u32_u24_sdwa v28, v23, v4 dst_sel:DWORD dst_unused:UNUSED_PAD src0_sel:WORD_0 src1_sel:DWORD
    v_mul_u32_u24_sdwa v29, v23, v5 dst_sel:DWORD dst_unused:UNUSED_PAD src0_sel:WORD_0 src1_sel:DWORD
    s_waitcnt vmcnt(30)
    v_mfma_f32_16x16x32_bf16 v[34:37], v[124:127], v[30:33], v[34:37]
    v_mov_b32_dpp v22, v20 row_newbcast:2 row_mask:0xf bank_mask:0x3
    s_nop 1
    v_mov_b32_dpp v22, v20 row_newbcast:10 row_mask:0xf bank_mask:0xc
    v_mul_u32_u24_sdwa v30, v23, v2 dst_sel:DWORD dst_unused:UNUSED_PAD src0_sel:WORD_1 src1_sel:DWORD
    v_mul_u32_u24_sdwa v31, v23, v3 dst_sel:DWORD dst_unused:UNUSED_PAD src0_sel:WORD_1 src1_sel:DWORD
    v_mul_u32_u24_sdwa v32, v23, v4 dst_sel:DWORD dst_unused:UNUSED_PAD src0_sel:WORD_1 src1_sel:DWORD
    v_mul_u32_u24_sdwa v33, v23, v5 dst_sel:DWORD dst_unused:UNUSED_PAD src0_sel:WORD_1 src1_sel:DWORD
    s_waitcnt vmcnt(29)
    v_mfma_f32_16x16x32_bf16 v[34:37], v[128:131], v[26:29], v[34:37]
    v_mul_u32_u24_sdwa v26, v22, v2 dst_sel:DWORD dst_unused:UNUSED_PAD src0_sel:WORD_0 src1_sel:DWORD
    v_mul_u32_u24_sdwa v27, v22, v3 dst_sel:DWORD dst_unused:UNUSED_PAD src0_sel:WORD_0 src1_sel:DWORD
    v_mul_u32_u24_sdwa v28, v22, v4 dst_sel:DWORD dst_unused:UNUSED_PAD src0_sel:WORD_0 src1_sel:DWORD
    v_mul_u32_u24_sdwa v29, v22, v5 dst_sel:DWORD dst_unused:UNUSED_PAD src0_sel:WORD_0 src1_sel:DWORD
    s_waitcnt vmcnt(28)
    v_mfma_f32_16x16x32_bf16 v[34:37], v[132:135], v[30:33], v[34:37]
    v_mov_b32_dpp v23, v20 row_newbcast:3 row_mask:0xf bank_mask:0x3
    s_nop 1
    v_mov_b32_dpp v23, v20 row_newbcast:11 row_mask:0xf bank_mask:0xc
    v_mul_u32_u24_sdwa v30, v22, v2 dst_sel:DWORD dst_unused:UNUSED_PAD src0_sel:WORD_1 src1_sel:DWORD
    v_mul_u32_u24_sdwa v31, v22, v3 dst_sel:DWORD dst_unused:UNUSED_PAD src0_sel:WORD_1 src1_sel:DWORD
    v_mul_u32_u24_sdwa v32, v22, v4 dst_sel:DWORD dst_unused:UNUSED_PAD src0_sel:WORD_1 src1_sel:DWORD
    v_mul_u32_u24_sdwa v33, v22, v5 dst_sel:DWORD dst_unused:UNUSED_PAD src0_sel:WORD_1 src1_sel:DWORD
    s_waitcnt vmcnt(27)
    v_mfma_f32_16x16x32_bf16 v[34:37], v[136:139], v[26:29], v[34:37]
    v_mul_u32_u24_sdwa v26, v23, v2 dst_sel:DWORD dst_unused:UNUSED_PAD src0_sel:WORD_0 src1_sel:DWORD
    v_mul_u32_u24_sdwa v27, v23, v3 dst_sel:DWORD dst_unused:UNUSED_PAD src0_sel:WORD_0 src1_sel:DWORD
    v_mul_u32_u24_sdwa v28, v23, v4 dst_sel:DWORD dst_unused:UNUSED_PAD src0_sel:WORD_0 src1_sel:DWORD
    v_mul_u32_u24_sdwa v29, v23, v5 dst_sel:DWORD dst_unused:UNUSED_PAD src0_sel:WORD_0 src1_sel:DWORD
    s_waitcnt vmcnt(26)
    v_mfma_f32_16x16x32_bf16 v[34:37], v[140:143], v[30:33], v[34:37]
    v_mov_b32_dpp v22, v20 row_newbcast:4 row_mask:0xf bank_mask:0x3
    s_nop 1
    v_mov_b32_dpp v22, v20 row_newbcast:12 row_mask:0xf bank_mask:0xc
    v_mul_u32_u24_sdwa v30, v23, v2 dst_sel:DWORD dst_unused:UNUSED_PAD src0_sel:WORD_1 src1_sel:DWORD
    v_mul_u32_u24_sdwa v31, v23, v3 dst_sel:DWORD dst_unused:UNUSED_PAD src0_sel:WORD_1 src1_sel:DWORD
    v_mul_u32_u24_sdwa v32, v23, v4 dst_sel:DWORD dst_unused:UNUSED_PAD src0_sel:WORD_1 src1_sel:DWORD
    v_mul_u32_u24_sdwa v33, v23, v5 dst_sel:DWORD dst_unused:UNUSED_PAD src0_sel:WORD_1 src1_sel:DWORD
    s_waitcnt vmcnt(25)
    v_mfma_f32_16x16x32_bf16 v[34:37], v[144:147], v[26:29], v[34:37]
    v_mul_u32_u24_sdwa v26, v22, v2 dst_sel:DWORD dst_unused:UNUSED_PAD src0_sel:WORD_0 src1_sel:DWORD
    v_mul_u32_u24_sdwa v27, v22, v3 dst_sel:DWORD dst_unused:UNUSED_PAD src0_sel:WORD_0 src1_sel:DWORD
    v_mul_u32_u24_sdwa v28, v22, v4 dst_sel:DWORD dst_unused:UNUSED_PAD src0_sel:WORD_0 src1_sel:DWORD
    v_mul_u32_u24_sdwa v29, v22, v5 dst_sel:DWORD dst_unused:UNUSED_PAD src0_sel:WORD_0 src1_sel:DWORD
    s_waitcnt vmcnt(24)
    v_mfma_f32_16x16x32_bf16 v[34:37], v[148:151], v[30:33], v[34:37]
    v_mul_u32_u24_sdwa v30, v22, v2 dst_sel:DWORD dst_unused:UNUSED_PAD src0_sel:WORD_1 src1_sel:DWORD
    v_mul_u32_u24_sdwa v31, v22, v3 dst_sel:DWORD dst_unused:UNUSED_PAD src0_sel:WORD_1 src1_sel:DWORD
    v_mul_u32_u24_sdwa v32, v22, v4 dst_sel:DWORD dst_unused:UNUSED_PAD src0_sel:WORD_1 src1_sel:DWORD
    v_mul_u32_u24_sdwa v33, v22, v5 dst_sel:DWORD dst_unused:UNUSED_PAD src0_sel:WORD_1 src1_sel:DWORD
    s_waitcnt vmcnt(23)
    v_mfma_f32_16x16x32_bf16 v[34:37], v[152:155], v[26:29], v[34:37]
    s_waitcnt vmcnt(22)
    v_mfma_f32_16x16x32_bf16 v[34:37], v[156:159], v[30:33], v[34:37]
    s_nop 7
    v_permlane32_swap_b32 v34, v35
    v_permlane32_swap_b32 v36, v37
    s_nop 0
    v_add_f32_dpp v34, v35, v34 row_ror:8 row_mask:0xf bank_mask:0xf
    v_add_f32_dpp v36, v37, v36 row_ror:8 row_mask:0xf bank_mask:0xf
    s_mov_b32 exec_lo, 0x00ff00ff
    s_mov_b32 exec_hi, 0x00ff00ff
    ds_write2_b32 v18, v34, v36 offset0:0 offset1:16
    s_mov_b64 exec, 1
    ds_add_rtn_u32 v7, v6, v8 offset:0
    s_mov_b64 exec, -1
    ds_read2st64_b32 v[20:21], v19 offset0:1 offset1:2
    s_waitcnt lgkmcnt(0)
    v_readfirstlane_b32 s98, v7
    s_cmp_lg_u32 s98, 1
    s_nop 2
    s_cbranch_scc1 L_c1
    v_add_f32 v38, v20, v21
    buffer_store_dwordx2 v[38:39], v13, s[32:35], s83 offen sc1
L_c1:
    v_add_u32 v18, 512, v18
    s_waitcnt vmcnt(20)
    v_lshlrev_b32 v20, 16, v160
    v_and_b32 v21, 0xffff0000, v160
    v_lshlrev_b32 v22, 16, v161
    v_and_b32 v23, 0xffff0000, v161
    v_max_f32 v24, 0xc2ae0000, v20
    v_sub_f32 v24, 0, v24
    v_max_f32 v25, 0xc2ae0000, v21
    v_sub_f32 v25, 0, v25
    v_max_f32 v26, 0xc2ae0000, v22
    v_sub_f32 v26, 0, v26
    v_max_f32 v27, 0xc2ae0000, v23
    v_sub_f32 v27, 0, v27
    v_mul_f32 v28, 0x3fb8aa3b, v24
    v_mul_f32 v29, 0x3fb8aa3b, v25
    v_mul_f32 v30, 0x3fb8aa3b, v26
    v_mul_f32 v31, 0x3fb8aa3b, v27
    s_mov_b32 s96, 0x3fb8aa3b
    s_mov_b32 s97, 0x32a57060
    v_fma_f32 v32, v24, s96, -v28
    v_fma_f32 v33, v25, s96, -v29
    v_fma_f32 v34, v26, s96, -v30
    v_fma_f32 v35, v27, s96, -v31
    v_fma_f32 v32, v24, s97, v32
    v_fma_f32 v33, v25, s97, v33
    v_fma_f32 v34, v26, s97, v34
    v_fma_f32 v35, v27, s97, v35
    v_exp_f32 v28, v28
    v_exp_f32 v29, v29
    v_exp_f32 v30, v30
    v_exp_f32 v31, v31
    v_mul_f32 v32, 0x3f317218, v32
    v_mul_f32 v33, 0x3f317218, v33
    v_mul_f32 v34, 0x3f317218, v34
    v_mul_f32 v35, 0x3f317218, v35
    v_fma_f32 v24, v28, v32, v28
    v_fma_f32 v25, v29, v33, v29
    v_fma_f32 v26, v30, v34, v30
    v_fma_f32 v27, v31, v35, v31
    v_add_f32 v24, 1.0, v24
    v_add_f32 v25, 1.0, v25
    v_add_f32 v26, 1.0, v26
    v_add_f32 v27, 1.0, v27
    v_rcp_f32 v28, v24
    v_rcp_f32 v29, v25
    v_rcp_f32 v30, v26
    v_rcp_f32 v31, v27
    v_fma_f32 v32, -v24, v28, 1.0
    v_fma_f32 v33, -v25, v29, 1.0
    v_fma_f32 v34, -v26, v30, 1.0
    v_fma_f32 v35, -v27, v31, 1.0
    v_fma_f32 v28, v32, v28, v28
    v_fma_f32 v29, v33, v29, v29
    v_fma_f32 v30, v34, v30, v30
    v_fma_f32 v31, v35, v31, v31
    v_mul_f32 v32, v20, v28
    v_mul_f32 v33, v21, v29
    v_mul_f32 v34, v22, v30
    v_mul_f32 v35, v23, v31
    v_fma_f32 v20, -v32, v24, v20
    v_fma_f32 v21, -v33, v25, v21
    v_fma_f32 v22, -v34, v26, v22
    v_fma_f32 v23, -v35, v27, v23
    v_fma_f32 v20, v20, v28, v32
    v_fma_f32 v21, v21, v29, v33
    v_fma_f32 v22, v22, v30, v34
    v_fma_f32 v23, v23, v31, v35
    v_cvt_pk_bf16_f32 v20, v20, v21
    v_cvt_pk_bf16_f32 v21, v22, v23
    s_nop 0
    s_branch L_g20
L_idle:
    s_waitcnt lgkmcnt(0)
    s_load_dword s52, s[30:31], 0
    s_barrier
    s_endpgm
L_fe2:
    s_mul_i32 s66, s54, 160
    s_lshl1_add_u32 s65, s53, s3
    s_mul_i32 s68, s66, 8192
    s_lshl_b32 s69, s65, 7
    s_add_u32 s68, s68, s69
    v_mul_u32_u24 v17, 8192, v9
    v_lshl_add_u32 v16, v17, 4, v15
    v_lshl_add_u32 v17, v17, 2, v15
    v_add_u32 v17, 917504, v17
    s_lshl_b32 s67, s66, 1
    v_lshl_add_u32 v11, v0, 2, s67
    v_lshrrev_b32 v14, 2, v0
    v_lshl_add_u32 v12, v14, 2, s67
    v_lshlrev_b32 v13, 4, v0
    v_lshlrev_b32 v19, 2, v0
    s_waitcnt lgkmcnt(0)
    s_load_dword s52, s[30:31], 0
    s_mov_b32 s40, s10
    s_mov_b32 s41, s11
    s_mov_b32 s42, 5242880
    s_mov_b32 s43, 0x20000
    global_load_dword v160, v11, s[4:5]
    global_load_dword v161, v12, s[4:5] offset:256
    global_load_dwordx4 v[162:165], v13, s[4:5]
    global_load_dword v166, v19, s[4:5] offset:1024
    s_movk_i32 s64, 8192
    buffer_load_dwordx4 v[40:43], v16, s[40:43], s68 offen nt
    s_add_u32 s68, s68, s64
    buffer_load_dwordx4 v[44:47], v16, s[40:43], s68 offen nt
    s_add_u32 s68, s68, s64
    buffer_load_dwordx4 v[48:51], v16, s[40:43], s68 offen nt
    s_add_u32 s68, s68, s64
    buffer_load_dwordx4 v[52:55], v16, s[40:43], s68 offen nt
    s_add_u32 s68, s68, s64
    buffer_load_dwordx4 v[56:59], v16, s[40:43], s68 offen nt
    s_add_u32 s68, s68, s64
    buffer_load_dwordx4 v[60:63], v16, s[40:43], s68 offen nt
    s_add_u32 s68, s68, s64
    buffer_load_dwordx4 v[64:67], v16, s[40:43], s68 offen nt
    s_add_u32 s68, s68, s64
    buffer_load_dwordx4 v[68:71], v16, s[40:43], s68 offen nt
    s_add_u32 s68, s68, s64
    buffer_load_dwordx4 v[72:75], v16, s[40:43], s68 offen nt
    s_add_u32 s68, s68, s64
    buffer_load_dwordx4 v[76:79], v16, s[40:43], s68 offen nt
    s_add_u32 s68, s68, s64
    buffer_load_dwordx4 v[80:83], v16, s[40:43], s68 offen nt
    s_add_u32 s68, s68, s64
    buffer_load_dwordx4 v[84:87], v16, s[40:43], s68 offen nt
    s_add_u32 s68, s68, s64
    buffer_load_dwordx4 v[88:91], v16, s[40:43], s68 offen nt
    s_add_u32 s68, s68, s64
    buffer_load_dwordx4 v[92:95], v16, s[40:43], s68 offen nt
    s_add_u32 s68, s68, s64
    buffer_load_dwordx4 v[96:99], v16, s[40:43], s68 offen nt
    s_add_u32 s68, s68, s64
    buffer_load_dwordx4 v[100:103], v16, s[40:43], s68 offen nt
    s_add_u32 s68, s68, s64
    buffer_load_dwordx4 v[104:107], v17, s[40:43], s68 offen nt
    s_add_u32 s68, s68, s64
    buffer_load_dwordx4 v[108:111], v17, s[40:43], s68 offen nt
    s_add_u32 s68, s68, s64
    buffer_load_dwordx4 v[112:115], v17, s[40:43], s68 offen nt
    s_add_u32 s68, s68, s64
    buffer_load_dwordx4 v[116:119], v17, s[40:43], s68 offen nt
    s_barrier
    s_lshl2_add_u32 s79, s53, s54
    s_lshl1_add_u32 s79, s79, s3
    s_lshl_b32 s79, s79, 9
    s_add_u32 s79, s79, 86016
    s_mov_b32 s32, s30
    s_mov_b32 s33, s31
    s_mov_b32 s34, 660736
    s_mov_b32 s35, 0x20000
    v_and_b32 v8, 1, v0
    v_lshlrev_b32 v8, 4, v8
    v_lshlrev_b32_e64 v8, v8, 1
    v_bfe_u32 v7, v0, 1, 2
    v_cmp_eq_u32 vcc, 0, v7
    s_nop 1
    v_cndmask_b32 v2, 0, v8, vcc
    v_cmp_eq_u32 vcc, 1, v7
    s_nop 1
    v_cndmask_b32 v3, 0, v8, vcc
    v_cmp_eq_u32 vcc, 2, v7
    s_nop 1
    v_cndmask_b32 v4, 0, v8, vcc
    v_cmp_eq_u32 vcc, 3, v7
    s_nop 1
    v_cndmask_b32 v5, 0, v8, vcc
    s_waitcnt lgkmcnt(0)
    s_mul_i32 s52, s52, 0x5bd1e9c5
    s_add_u32 s52, s52, 0x6a09e6b7
    v_mov_b32 v39, s52
    s_waitcnt vmcnt(20)
    v_lshlrev_b32 v20, 16, v160
    v_and_b32 v21, 0xffff0000, v160
    v_lshlrev_b32 v22, 16, v161
    v_and_b32 v23, 0xffff0000, v161
    v_lshlrev_b32 v120, 16, v162
    v_and_b32 v121, 0xffff0000, v162
    v_lshlrev_b32 v122, 16, v163
    v_and_b32 v123, 0xffff0000, v163
    v_lshlrev_b32 v124, 16, v164
    v_and_b32 v125, 0xffff0000, v164
    v_lshlrev_b32 v126, 16, v165
    v_and_b32 v127, 0xffff0000, v165
    v_lshlrev_b32 v128, 16, v166
    v_and_b32 v129, 0xffff0000, v166
    v_add_f32 v24, v120, v121
    v_add_f32 v27, v122, v123
    v_add_f32 v24, v24, v124
    v_add_f32 v27, v27, v125
    v_add_f32 v24, v24, v126
    v_add_f32 v27, v27, v127
    v_add_f32 v24, v24, v128
    v_add_f32 v27, v27, v129
    v_add_f32 v24, v24, v27
    s_nop 1
    v_add_f32_dpp v24, v24, v24 row_ror:8 row_mask:0xf bank_mask:0xf
    s_nop 1
    v_add_f32_dpp v24, v24, v24 row_ror:4 row_mask:0xf bank_mask:0xf
    s_nop 1
    v_add_f32_dpp v24, v24, v24 row_ror:2 row_mask:0xf bank_mask:0xf
    s_nop 1
    v_add_f32_dpp v24, v24, v24 row_ror:1 row_mask:0xf bank_mask:0xf
    v_mov_b32 v27, v24
    s_nop 1
    v_permlane16_swap_b32 v24, v27
    v_add_f32 v24, v24, v27
    v_mov_b32 v27, v24
    s_nop 1
    v_permlane32_swap_b32 v24, v27
    v_add_f32 v24, v24, v27
    s_mov_b32 s96, 0x44200000
    s_mov_b32 s97, 0x3acccccd
    v_mul_f32 v27, v24, s97
    v_fma_f32 v24, -v27, s96, v24
    v_fma_f32 v24, v24, s97, v27
    v_sub_f32 v120, v120, v24
    v_sub_f32 v121, v121, v24
    v_sub_f32 v122, v122, v24
    v_sub_f32 v123, v123, v24
    v_sub_f32 v124, v124, v24
    v_sub_f32 v125, v125, v24
    v_sub_f32 v126, v126, v24
    v_sub_f32 v127, v127, v24
    v_sub_f32 v128, v128, v24
    v_sub_f32 v129, v129, v24
    v_mul_f32 v25, v120, v120
    v_mul_f32 v27, v121, v121
    v_fmac_f32 v25, v122, v122
    v_fmac_f32 v27, v123, v123
    v_fmac_f32 v25, v124, v124
    v_fmac_f32 v27, v125, v125
    v_fmac_f32 v25, v126, v126
    v_fmac_f32 v27, v127, v127
    v_fmac_f32 v25, v128, v128
    v_fmac_f32 v27, v129, v129
    v_add_f32 v25, v25, v27
    s_nop 1
    v_add_f32_dpp v25, v25, v25 row_ror:8 row_mask:0xf bank_mask:0xf
    s_nop 1
    v_add_f32_dpp v25, v25, v25 row_ror:4 row_mask:0xf bank_mask:0xf
    s_nop 1
    v_add_f32_dpp v25, v25, v25 row_ror:2 row_mask:0xf bank_mask:0xf
    s_nop 1
    v_add_f32_dpp v25, v25, v25 row_ror:1 row_mask:0xf bank_mask:0xf
    v_mov_b32 v27, v25
    s_nop 1
    v_permlane16_swap_b32 v25, v27
    v_add_f32 v25, v25, v27
    v_mov_b32 v27, v25
    s_nop 1
    v_permlane32_swap_b32 v25, v27
    v_add_f32 v25, v25, v27
    v_mul_f32 v27, v25, s97
    v_fma_f32 v25, -v27, s96, v25
    v_fma_f32 v25, v25, s97, v27
    v_cvt_pk_bf16_f32 v25, v24, v25
    v_lshlrev_b32 v24, 16, v25
    v_and_b32 v25, 0xffff0000, v25
    v_add_f32 v25, 0x3727c5ac, v25
    v_cvt_pk_bf16_f32 v25, v25, v25
    v_and_b32 v25, 0xffff0000, v25
    v_sqrt_f32 v27, v25
    v_rsq_f32 v28, v25
    v_fma_f32 v25, -v27, v27, v25
    v_mul_f32 v28, 0.5, v28
    v_fma_f32 v25, v25, v28, v27
    v_cvt_pk_bf16_f32 v25, v25, v25
    v_and_b32 v25, 0xffff0000, v25
    v_rcp_f32 v26, v25
    s_nop 0
    v_fma_f32 v27, -v25, v26, 1.0
    v_fma_f32 v26, v27, v26, v26
    v_sub_f32 v20, v20, v24
    v_sub_f32 v21, v21, v24
    v_sub_f32 v22, v22, v24
    v_sub_f32 v23, v23, v24
    v_cvt_pk_bf16_f32 v21, v20, v21
    v_cvt_pk_bf16_f32 v23, v22, v23
    v_lshlrev_b32 v20, 16, v21
    v_lshlrev_b32 v22, 16, v23
    v_and_b32 v21, 0xffff0000, v21
    v_and_b32 v23, 0xffff0000, v23
    v_mul_f32 v28, v20, v26
    v_mul_f32 v29, v21, v26
    v_mul_f32 v30, v22, v26
    v_mul_f32 v31, v23, v26
    v_fma_f32 v20, -v28, v25, v20
    v_fma_f32 v21, -v29, v25, v21
    v_fma_f32 v22, -v30, v25, v22
    v_fma_f32 v23, -v31, v25, v23
    v_fma_f32 v20, v20, v26, v28
    v_fma_f32 v21, v21, v26, v29
    v_fma_f32 v22, v22, v26, v30
    v_fma_f32 v23, v23, v26, v31
    v_cvt_pk_bf16_f32 v21, v20, v21
    v_cvt_pk_bf16_f32 v23, v22, v23
    v_lshlrev_b32 v20, 16, v21
    v_lshlrev_b32 v22, 16, v23
    v_and_b32 v21, 0xffff0000, v21
    v_and_b32 v23, 0xffff0000, v23
    s_lshl_b32 s80, s66, 3
    s_mul_i32 s81, s3, 20480
    s_add_u32 s80, s80, s81
    s_add_u32 s80, s80, 4096
    s_add_u32 s81, s80, 5120
    s_add_u32 s84, s80, 10240
    s_add_u32 s85, s81, 10240
    v_bfe_u32 v11, v0, 4, 1
    v_mul_u32_u24 v12, 5120, v11
    v_and_b32 v19, 15, v0
    v_lshl_add_u32 v12, v19, 4, v12
    s_mul_i32 s82, s3, 1280
    s_add_u32 s82, s82, 5632
    v_lshlrev_b32 v11, 3, v11
    v_lshl_add_u32 v11, v19, 4, v11
    v_add_u32 v11, s82, v11
    v_add_u32 v11, 1024, v11
    v_add_u32 v19, s82, v13
    v_lshlrev_b32 v14, 4, v14
P_1:
    buffer_load_dwordx4 v[120:123], v13, s[32:35], s80 offen sc1
    buffer_load_dwordx4 v[124:127], v13, s[32:35], s81 offen sc1
    buffer_load_dwordx4 v[128:131], v12, s[32:35], s80 offen offset:1024 sc1
    buffer_load_dwordx4 v[132:135], v13, s[32:35], s84 offen sc1
    buffer_load_dwordx4 v[136:139], v13, s[32:35], s85 offen sc1
    buffer_load_dwordx4 v[140:143], v12, s[32:35], s84 offen offset:1024 sc1
    s_waitcnt vmcnt(0)
    v_cmp_ne_u32 vcc, s52, v121
    v_cmp_ne_u32 s[96:97], s52, v123
    s_or_b64 vcc, vcc, s[96:97]
    v_cmp_ne_u32 s[96:97], s52, v125
    s_or_b64 vcc, vcc, s[96:97]
    v_cmp_ne_u32 s[96:97], s52, v127
    s_or_b64 vcc, vcc, s[96:97]
    v_cmp_ne_u32 s[96:97], s52, v129
    s_or_b64 vcc, vcc, s[96:97]
    v_cmp_ne_u32 s[96:97], s52, v131
    s_or_b64 vcc, vcc, s[96:97]
    v_cmp_ne_u32 s[96:97], s52, v133
    s_or_b64 vcc, vcc, s[96:97]
    v_cmp_ne_u32 s[96:97], s52, v135
    s_or_b64 vcc, vcc, s[96:97]
    v_cmp_ne_u32 s[96:97], s52, v137
    s_or_b64 vcc, vcc, s[96:97]
    v_cmp_ne_u32 s[96:97], s52, v139
    s_or_b64 vcc, vcc, s[96:97]
    v_cmp_ne_u32 s[96:97], s52, v141
    s_or_b64 vcc, vcc, s[96:97]
    v_cmp_ne_u32 s[96:97], s52, v143
    s_or_b64 vcc, vcc, s[96:97]
    s_cmp_eq_u64 vcc, 0
    s_nop 1
    s_cbranch_scc1 PD_2
    s_sub_u32 s99, s99, 16
    s_cbranch_scc0 P_1
    s_mov_b32 s99, 0
PD_2:
    v_add_f32 v120, v120, v132
    v_add_f32 v122, v122, v134
    v_add_f32 v124, v124, v136
    v_add_f32 v126, v126, v138
    v_add_f32 v128, v128, v140
    v_add_f32 v130, v130, v142
    ds_write2_b32 v19, v120, v122 offset0:0 offset1:1
    ds_write2_b32 v19, v124, v126 offset0:2 offset1:3
    ds_write2_b32 v11, v128, v130 offset0:0 offset1:1
    s_mov_b64 exec, 1
    v_mov_b32 v8, 1
    ds_add_u32 v6, v8 offset:8
    s_mov_b64 exec, -1
W_3:
    ds_read_b32 v7, v6 offset:8
    s_waitcnt lgkmcnt(0)
    v_readfirstlane_b32 s98, v7
    s_cmp_ge_u32 s98, 2
    s_nop 2
    s_cbranch_scc1 WD_4
    s_sleep 1
    s_sub_u32 s99, s99, 1
    s_cbranch_scc0 W_3
    s_mov_b32 s99, 0
WD_4:
    ds_read_b128 v[120:123], v13 offset:5632
    ds_read_b128 v[136:139], v14 offset:6656
    ds_read_b128 v[124:127], v13 offset:6912
    ds_read_b128 v[140:143], v14 offset:7936
    s_waitcnt lgkmcnt(0)
    v_pk_add_f32 v[120:121], v[120:121], v[124:125]
    v_pk_add_f32 v[122:123], v[122:123], v[126:127]
    v_pk_add_f32 v[136:137], v[136:137], v[140:141]
    v_pk_add_f32 v[138:139], v[138:139], v[142:143]
    v_cvt_pk_bf16_f32 v123, v122, v123
    v_cvt_pk_bf16_f32 v139, v138, v139
    v_cvt_pk_bf16_f32 v121, v120, v121
    v_cvt_pk_bf16_f32 v137, v136, v137
    v_lshlrev_b32 v122, 16, v123
    v_lshlrev_b32 v138, 16, v139
    v_lshlrev_b32 v120, 16, v121
    v_lshlrev_b32 v136, 16, v137
    v_and_b32 v123, 0xffff0000, v123
    v_and_b32 v139, 0xffff0000, v139
    v_and_b32 v121, 0xffff0000, v121
    v_and_b32 v137, 0xffff0000, v137
    v_add_f32 v122, 1.0, v122
    v_add_f32 v123, 1.0, v123
    v_add_f32 v138, 1.0, v138
    v_add_f32 v139, 1.0, v139
    v_cvt_pk_bf16_f32 v123, v122, v123
    v_cvt_pk_bf16_f32 v139, v138, v139
    v_lshlrev_b32 v122, 16, v123
    v_lshlrev_b32 v138, 16, v139
    v_and_b32 v123, 0xffff0000, v123
    v_and_b32 v139, 0xffff0000, v139
    v_mul_f32 v122, v122, v20
    v_mul_f32 v123, v123, v21
    v_mul_f32 v138, v138, v22
    v_mul_f32 v139, v139, v23
    v_cvt_pk_bf16_f32 v123, v122, v123
    v_cvt_pk_bf16_f32 v139, v138, v139
    v_lshlrev_b32 v122, 16, v123
    v_lshlrev_b32 v138, 16, v139
    v_and_b32 v123, 0xffff0000, v123
    v_and_b32 v139, 0xffff0000, v139
    v_add_f32 v120, v120, v122
    v_add_f32 v121, v121, v123
    v_add_f32 v136, v136, v138
    v_add_f32 v137, v137, v139
    v_cvt_pk_bf16_f32 v20, v120, v121
    v_cvt_pk_bf16_f32 v21, v136, v137
L_g20:
    v_bfe_u32 v11, v0, 3, 2
    v_lshlrev_b32 v11, 7, v11
    v_lshl_add_u32 v11, v10, 3, v11
    v_lshrrev_b32 v12, 5, v0
    v_lshl_add_u32 v11, v12, 6, v11
    v_mov_b32_dpp v22, v20 row_newbcast:0 row_mask:0xf bank_mask:0x3
    s_nop 1
    v_mov_b32_dpp v22, v20 row_newbcast:8 row_mask:0xf bank_mask:0xc
    v_mul_u32_u24_sdwa v26, v22, v2 dst_sel:DWORD dst_unused:UNUSED_PAD src0_sel:WORD_0 src1_sel:DWORD
    v_mul_u32_u24_sdwa v27, v22, v3 dst_sel:DWORD dst_unused:UNUSED_PAD src0_sel:WORD_0 src1_sel:DWORD
    v_mul_u32_u24_sdwa v28, v22, v4 dst_sel:DWORD dst_unused:UNUSED_PAD src0_sel:WORD_0 src1_sel:DWORD
    v_mul_u32_u24_sdwa v29, v22, v5 dst_sel:DWORD dst_unused:UNUSED_PAD src0_sel:WORD_0 src1_sel:DWORD
    v_mov_b32_dpp v23, v20 row_newbcast:1 row_mask:0xf bank_mask:0x3
    s_nop 1
    v_mov_b32_dpp v23, v20 row_newbcast:9 row_mask:0xf bank_mask:0xc
    v_mul_u32_u24_sdwa v30, v22, v2 dst_sel:DWORD dst_unused:UNUSED_PAD src0_sel:WORD_1 src1_sel:DWORD
    v_mul_u32_u24_sdwa v31, v22, v3 dst_sel:DWORD dst_unused:UNUSED_PAD src0_sel:WORD_1 src1_sel:DWORD
    v_mul_u32_u24_sdwa v32, v22, v4 dst_sel:DWORD dst_unused:UNUSED_PAD src0_sel:WORD_1 src1_sel:DWORD
    v_mul_u32_u24_sdwa v33, v22, v5 dst_sel:DWORD dst_unused:UNUSED_PAD src0_sel:WORD_1 src1_sel:DWORD
    s_waitcnt vmcnt(19)
    v_mfma_f32_16x16x32_bf16 v[34:37], v[40:43], v[26:29], 0
    v_mul_u32_u24_sdwa v26, v23, v2 dst_sel:DWORD dst_unused:UNUSED_PAD src0_sel:WORD_0 src1_sel:DWORD
    v_mul_u32_u24_sdwa v27, v23, v3 dst_sel:DWORD dst_unused:UNUSED_PAD src0_sel:WORD_0 src1_sel:DWORD
    v_mul_u32_u24_sdwa v28, v23, v4 dst_sel:DWORD dst_unused:UNUSED_PAD src0_sel:WORD_0 src1_sel:DWORD
    v_mul_u32_u24_sdwa v29, v23, v5 dst_sel:DWORD dst_unused:UNUSED_PAD src0_sel:WORD_0 src1_sel:DWORD
    s_waitcnt vmcnt(18)
    v_mfma_f32_16x16x32_bf16 v[34:37], v[44:47], v[30:33], v[34:37]
    v_mov_b32_dpp v22, v20 row_newbcast:2 row_mask:0xf bank_mask:0x3
    s_nop 1
    v_mov_b32_dpp v22, v20 row_newbcast:10 row_mask:0xf bank_mask:0xc
    v_mul_u32_u24_sdwa v30, v23, v2 dst_sel:DWORD dst_unused:UNUSED_PAD src0_sel:WORD_1 src1_sel:DWORD
    v_mul_u32_u24_sdwa v31, v23, v3 dst_sel:DWORD dst_unused:UNUSED_PAD src0_sel:WORD_1 src1_sel:DWORD
    v_mul_u32_u24_sdwa v32, v23, v4 dst_sel:DWORD dst_unused:UNUSED_PAD src0_sel:WORD_1 src1_sel:DWORD
    v_mul_u32_u24_sdwa v33, v23, v5 dst_sel:DWORD dst_unused:UNUSED_PAD src0_sel:WORD_1 src1_sel:DWORD
    s_waitcnt vmcnt(17)
    v_mfma_f32_16x16x32_bf16 v[34:37], v[48:51], v[26:29], v[34:37]
    v_mul_u32_u24_sdwa v26, v22, v2 dst_sel:DWORD dst_unused:UNUSED_PAD src0_sel:WORD_0 src1_sel:DWORD
    v_mul_u32_u24_sdwa v27, v22, v3 dst_sel:DWORD dst_unused:UNUSED_PAD src0_sel:WORD_0 src1_sel:DWORD
    v_mul_u32_u24_sdwa v28, v22, v4 dst_sel:DWORD dst_unused:UNUSED_PAD src0_sel:WORD_0 src1_sel:DWORD
    v_mul_u32_u24_sdwa v29, v22, v5 dst_sel:DWORD dst_unused:UNUSED_PAD src0_sel:WORD_0 src1_sel:DWORD
    s_waitcnt vmcnt(16)
    v_mfma_f32_16x16x32_bf16 v[34:37], v[52:55], v[30:33], v[34:37]
    v_mov_b32_dpp v23, v20 row_newbcast:3 row_mask:0xf bank_mask:0x3
    s_nop 1
    v_mov_b32_dpp v23, v20 row_newbcast:11 row_mask:0xf bank_mask:0xc
    v_mul_u32_u24_sdwa v30, v22, v2 dst_sel:DWORD dst_unused:UNUSED_PAD src0_sel:WORD_1 src1_sel:DWORD
    v_mul_u32_u24_sdwa v31, v22, v3 dst_sel:DWORD dst_unused:UNUSED_PAD src0_sel:WORD_1 src1_sel:DWORD
    v_mul_u32_u24_sdwa v32, v22, v4 dst_sel:DWORD dst_unused:UNUSED_PAD src0_sel:WORD_1 src1_sel:DWORD
    v_mul_u32_u24_sdwa v33, v22, v5 dst_sel:DWORD dst_unused:UNUSED_PAD src0_sel:WORD_1 src1_sel:DWORD
    s_waitcnt vmcnt(15)
    v_mfma_f32_16x16x32_bf16 v[34:37], v[56:59], v[26:29], v[34:37]
    v_mul_u32_u24_sdwa v26, v23, v2 dst_sel:DWORD dst_unused:UNUSED_PAD src0_sel:WORD_0 src1_sel:DWORD
    v_mul_u32_u24_sdwa v27, v23, v3 dst_sel:DWORD dst_unused:UNUSED_PAD src0_sel:WORD_0 src1_sel:DWORD
    v_mul_u32_u24_sdwa v28, v23, v4 dst_sel:DWORD dst_unused:UNUSED_PAD src0_sel:WORD_0 src1_sel:DWORD
    v_mul_u32_u24_sdwa v29, v23, v5 dst_sel:DWORD dst_unused:UNUSED_PAD src0_sel:WORD_0 src1_sel:DWORD
    s_waitcnt vmcnt(14)
    v_mfma_f32_16x16x32_bf16 v[34:37], v[60:63], v[30:33], v[34:37]
    v_mov_b32_dpp v22, v20 row_newbcast:4 row_mask:0xf bank_mask:0x3
    s_nop 1
    v_mov_b32_dpp v22, v20 row_newbcast:12 row_mask:0xf bank_mask:0xc
    v_mul_u32_u24_sdwa v30, v23, v2 dst_sel:DWORD dst_unused:UNUSED_PAD src0_sel:WORD_1 src1_sel:DWORD
    v_mul_u32_u24_sdwa v31, v23, v3 dst_sel:DWORD dst_unused:UNUSED_PAD src0_sel:WORD_1 src1_sel:DWORD
    v_mul_u32_u24_sdwa v32, v23, v4 dst_sel:DWORD dst_unused:UNUSED_PAD src0_sel:WORD_1 src1_sel:DWORD
    v_mul_u32_u24_sdwa v33, v23, v5 dst_sel:DWORD dst_unused:UNUSED_PAD src0_sel:WORD_1 src1_sel:DWORD
    s_waitcnt vmcnt(13)
    v_mfma_f32_16x16x32_bf16 v[34:37], v[64:67], v[26:29], v[34:37]
    v_mul_u32_u24_sdwa v26, v22, v2 dst_sel:DWORD dst_unused:UNUSED_PAD src0_sel:WORD_0 src1_sel:DWORD
    v_mul_u32_u24_sdwa v27, v22, v3 dst_sel:DWORD dst_unused:UNUSED_PAD src0_sel:WORD_0 src1_sel:DWORD
    v_mul_u32_u24_sdwa v28, v22, v4 dst_sel:DWORD dst_unused:UNUSED_PAD src0_sel:WORD_0 src1_sel:DWORD
    v_mul_u32_u24_sdwa v29, v22, v5 dst_sel:DWORD dst_unused:UNUSED_PAD src0_sel:WORD_0 src1_sel:DWORD
    s_waitcnt vmcnt(12)
    v_mfma_f32_16x16x32_bf16 v[34:37], v[68:71], v[30:33], v[34:37]
    v_mov_b32_dpp v23, v20 row_newbcast:5 row_mask:0xf bank_mask:0x3
    s_nop 1
    v_mov_b32_dpp v23, v20 row_newbcast:13 row_mask:0xf bank_mask:0xc
    v_mul_u32_u24_sdwa v30, v22, v2 dst_sel:DWORD dst_unused:UNUSED_PAD src0_sel:WORD_1 src1_sel:DWORD
    v_mul_u32_u24_sdwa v31, v22, v3 dst_sel:DWORD dst_unused:UNUSED_PAD src0_sel:WORD_1 src1_sel:DWORD
    v_mul_u32_u24_sdwa v32, v22, v4 dst_sel:DWORD dst_unused:UNUSED_PAD src0_sel:WORD_1 src1_sel:DWORD
    v_mul_u32_u24_sdwa v33, v22, v5 dst_sel:DWORD dst_unused:UNUSED_PAD src0_sel:WORD_1 src1_sel:DWORD
    s_waitcnt vmcnt(11)
    v_mfma_f32_16x16x32_bf16 v[34:37], v[72:75], v[26:29], v[34:37]
    v_mul_u32_u24_sdwa v26, v23, v2 dst_sel:DWORD dst_unused:UNUSED_PAD src0_sel:WORD_0 src1_sel:DWORD
    v_mul_u32_u24_sdwa v27, v23, v3 dst_sel:DWORD dst_unused:UNUSED_PAD src0_sel:WORD_0 src1_sel:DWORD
    v_mul_u32_u24_sdwa v28, v23, v4 dst_sel:DWORD dst_unused:UNUSED_PAD src0_sel:WORD_0 src1_sel:DWORD
    v_mul_u32_u24_sdwa v29, v23, v5 dst_sel:DWORD dst_unused:UNUSED_PAD src0_sel:WORD_0 src1_sel:DWORD
    s_waitcnt vmcnt(10)
    v_mfma_f32_16x16x32_bf16 v[34:37], v[76:79], v[30:33], v[34:37]
    v_mov_b32_dpp v22, v20 row_newbcast:6 row_mask:0xf bank_mask:0x3
    s_nop 1
    v_mov_b32_dpp v22, v20 row_newbcast:14 row_mask:0xf bank_mask:0xc
    v_mul_u32_u24_sdwa v30, v23, v2 dst_sel:DWORD dst_unused:UNUSED_PAD src0_sel:WORD_1 src1_sel:DWORD
    v_mul_u32_u24_sdwa v31, v23, v3 dst_sel:DWORD dst_unused:UNUSED_PAD src0_sel:WORD_1 src1_sel:DWORD
    v_mul_u32_u24_sdwa v32, v23, v4 dst_sel:DWORD dst_unused:UNUSED_PAD src0_sel:WORD_1 src1_sel:DWORD
    v_mul_u32_u24_sdwa v33, v23, v5 dst_sel:DWORD dst_unused:UNUSED_PAD src0_sel:WORD_1 src1_sel:DWORD
    s_waitcnt vmcnt(9)
    v_mfma_f32_16x16x32_bf16 v[34:37], v[80:83], v[26:29], v[34:37]
    v_mul_u32_u24_sdwa v26, v22, v2 dst_sel:DWORD dst_unused:UNUSED_PAD src0_sel:WORD_0 src1_sel:DWORD
    v_mul_u32_u24_sdwa v27, v22, v3 dst_sel:DWORD dst_unused:UNUSED_PAD src0_sel:WORD_0 src1_sel:DWORD
    v_mul_u32_u24_sdwa v28, v22, v4 dst_sel:DWORD dst_unused:UNUSED_PAD src0_sel:WORD_0 src1_sel:DWORD
    v_mul_u32_u24_sdwa v29, v22, v5 dst_sel:DWORD dst_unused:UNUSED_PAD src0_sel:WORD_0 src1_sel:DWORD
    s_waitcnt vmcnt(8)
    v_mfma_f32_16x16x32_bf16 v[34:37], v[84:87], v[30:33], v[34:37]
    v_mov_b32_dpp v23, v20 row_newbcast:7 row_mask:0xf bank_mask:0x3
    s_nop 1
    v_mov_b32_dpp v23, v20 row_newbcast:15 row_mask:0xf bank_mask:0xc
    v_mul_u32_u24_sdwa v30, v22, v2 dst_sel:DWORD dst_unused:UNUSED_PAD src0_sel:WORD_1 src1_sel:DWORD
    v_mul_u32_u24_sdwa v31, v22, v3 dst_sel:DWORD dst_unused:UNUSED_PAD src0_sel:WORD_1 src1_sel:DWORD
    v_mul_u32_u24_sdwa v32, v22, v4 dst_sel:DWORD dst_unused:UNUSED_PAD src0_sel:WORD_1 src1_sel:DWORD
    v_mul_u32_u24_sdwa v33, v22, v5 dst_sel:DWORD dst_unused:UNUSED_PAD src0_sel:WORD_1 src1_sel:DWORD
    s_waitcnt vmcnt(7)
    v_mfma_f32_16x16x32_bf16 v[34:37], v[88:91], v[26:29], v[34:37]
    v_mul_u32_u24_sdwa v26, v23, v2 dst_sel:DWORD dst_unused:UNUSED_PAD src0_sel:WORD_0 src1_sel:DWORD
    v_mul_u32_u24_sdwa v27, v23, v3 dst_sel:DWORD dst_unused:UNUSED_PAD src0_sel:WORD_0 src1_sel:DWORD
    v_mul_u32_u24_sdwa v28, v23, v4 dst_sel:DWORD dst_unused:UNUSED_PAD src0_sel:WORD_0 src1_sel:DWORD
    v_mul_u32_u24_sdwa v29, v23, v5 dst_sel:DWORD dst_unused:UNUSED_PAD src0_sel:WORD_0 src1_sel:DWORD
    s_waitcnt vmcnt(6)
    v_mfma_f32_16x16x32_bf16 v[34:37], v[92:95], v[30:33], v[34:37]
    v_mov_b32_dpp v22, v21 row_newbcast:0 row_mask:0xf bank_mask:0x3
    s_nop 1
    v_mov_b32_dpp v22, v21 row_newbcast:8 row_mask:0xf bank_mask:0xc
    v_mul_u32_u24_sdwa v30, v23, v2 dst_sel:DWORD dst_unused:UNUSED_PAD src0_sel:WORD_1 src1_sel:DWORD
    v_mul_u32_u24_sdwa v31, v23, v3 dst_sel:DWORD dst_unused:UNUSED_PAD src0_sel:WORD_1 src1_sel:DWORD
    v_mul_u32_u24_sdwa v32, v23, v4 dst_sel:DWORD dst_unused:UNUSED_PAD src0_sel:WORD_1 src1_sel:DWORD
    v_mul_u32_u24_sdwa v33, v23, v5 dst_sel:DWORD dst_unused:UNUSED_PAD src0_sel:WORD_1 src1_sel:DWORD
    s_waitcnt vmcnt(5)
    v_mfma_f32_16x16x32_bf16 v[34:37], v[96:99], v[26:29], v[34:37]
    v_mul_u32_u24_sdwa v26, v22, v2 dst_sel:DWORD dst_unused:UNUSED_PAD src0_sel:WORD_0 src1_sel:DWORD
    v_mul_u32_u24_sdwa v27, v22, v3 dst_sel:DWORD dst_unused:UNUSED_PAD src0_sel:WORD_0 src1_sel:DWORD
    v_mul_u32_u24_sdwa v28, v22, v4 dst_sel:DWORD dst_unused:UNUSED_PAD src0_sel:WORD_0 src1_sel:DWORD
    v_mul_u32_u24_sdwa v29, v22, v5 dst_sel:DWORD dst_unused:UNUSED_PAD src0_sel:WORD_0 src1_sel:DWORD
    s_waitcnt vmcnt(4)
    v_mfma_f32_16x16x32_bf16 v[34:37], v[100:103], v[30:33], v[34:37]
    v_mov_b32_dpp v23, v21 row_newbcast:4 row_mask:0xf bank_mask:0x3
    s_nop 1
    v_mov_b32_dpp v23, v21 row_newbcast:12 row_mask:0xf bank_mask:0xc
    v_mul_u32_u24_sdwa v30, v22, v2 dst_sel:DWORD dst_unused:UNUSED_PAD src0_sel:WORD_1 src1_sel:DWORD
    v_mul_u32_u24_sdwa v31, v22, v3 dst_sel:DWORD dst_unused:UNUSED_PAD src0_sel:WORD_1 src1_sel:DWORD
    v_mul_u32_u24_sdwa v32, v22, v4 dst_sel:DWORD dst_unused:UNUSED_PAD src0_sel:WORD_1 src1_sel:DWORD
    v_mul_u32_u24_sdwa v33, v22, v5 dst_sel:DWORD dst_unused:UNUSED_PAD src0_sel:WORD_1 src1_sel:DWORD
    s_waitcnt vmcnt(3)
    v_mfma_f32_16x16x32_bf16 v[34:37], v[104:107], v[26:29], v[34:37]
    v_mul_u32_u24_sdwa v26, v23, v2 dst_sel:DWORD dst_unused:UNUSED_PAD src0_sel:WORD_0 src1_sel:DWORD
    v_mul_u32_u24_sdwa v27, v23, v3 dst_sel:DWORD dst_unused:UNUSED_PAD src0_sel:WORD_0 src1_sel:DWORD
    v_mul_u32_u24_sdwa v28, v23, v4 dst_sel:DWORD dst_unused:UNUSED_PAD src0_sel:WORD_0 src1_sel:DWORD
    v_mul_u32_u24_sdwa v29, v23, v5 dst_sel:DWORD dst_unused:UNUSED_PAD src0_sel:WORD_0 src1_sel:DWORD
    s_waitcnt vmcnt(2)
    v_mfma_f32_16x16x32_bf16 v[34:37], v[108:111], v[30:33], v[34:37]
    v_mul_u32_u24_sdwa v30, v23, v2 dst_sel:DWORD dst_unused:UNUSED_PAD src0_sel:WORD_1 src1_sel:DWORD
    v_mul_u32_u24_sdwa v31, v23, v3 dst_sel:DWORD dst_unused:UNUSED_PAD src0_sel:WORD_1 src1_sel:DWORD
    v_mul_u32_u24_sdwa v32, v23, v4 dst_sel:DWORD dst_unused:UNUSED_PAD src0_sel:WORD_1 src1_sel:DWORD
    v_mul_u32_u24_sdwa v33, v23, v5 dst_sel:DWORD dst_unused:UNUSED_PAD src0_sel:WORD_1 src1_sel:DWORD
    s_waitcnt vmcnt(1)
    v_mfma_f32_16x16x32_bf16 v[34:37], v[112:115], v[26:29], v[34:37]
    s_waitcnt vmcnt(0)
    v_mfma_f32_16x16x32_bf16 v[34:37], v[116:119], v[30:33], v[34:37]
    s_cmp_ge_u32 s54, 4
    s_nop 5
    s_cbranch_scc1 L_g20m
    v_permlane32_swap_b32 v34, v35
    v_permlane32_swap_b32 v36, v37
    s_nop 0
    v_add_f32_dpp v38, v35, v34 row_ror:8 row_mask:0xf bank_mask:0x3
    s_nop 1
    v_add_f32_dpp v38, v36, v37 row_ror:8 row_mask:0xf bank_mask:0xc
    buffer_store_dwordx2 v[38:39], v11, s[32:35], s79 offen sc1
    s_branch L_g20f
L_g20m:
    v_permlane32_swap_b32 v34, v35
    v_permlane32_swap_b32 v36, v37
    s_nop 0
    v_add_f32_dpp v34, v35, v34 row_ror:8 row_mask:0xf bank_mask:0xf
    v_add_f32_dpp v36, v37, v36 row_ror:8 row_mask:0xf bank_mask:0xf
    s_mov_b32 exec_lo, 0x00ff00ff
    s_mov_b32 exec_hi, 0x00ff00ff
    ds_write2_b32 v18, v34, v36 offset0:0 offset1:16
    s_mov_b64 exec, 1
    ds_add_rtn_u32 v7, v6, v8 offset:4
    s_mov_b64 exec, -1
    ds_read2st64_b32 v[20:21], v19 offset0:3 offset1:4
    s_waitcnt lgkmcnt(0)
    v_readfirstlane_b32 s98, v7
    s_cmp_lg_u32 s98, 1
    s_nop 2
    s_cbranch_scc1 L_g20f
    v_add_f32 v38, v20, v21
    buffer_store_dwordx2 v[38:39], v13, s[32:35], s79 offen sc1
L_g20f:
    s_endpgm
L_kv:
    s_sub_u32 s50, s3, 2
    s_sub_u32 s64, s3, 7
    s_cmp_ge_u32 s3, 7
    s_cmov_b32 s50, s64
    s_mov_b32 s66, 941953792
    s_mov_b32 s67, 7232586
    s_mov_b32 s68, 321065763
    s_mov_b32 s69, 1250067
    s_lshl_b32 s64, s54, 3
    s_lshr_b64 s[66:67], s[66:67], s64
    s_lshr_b64 s[68:69], s[68:69], s64
    s_and_b32 s66, s66, 0xff
    s_lshl4_add_u32 s66, s64, s66
    s_bfe_u32 s69, s68, 0x30004
    s_and_b32 s49, s68, 15
    s_sub_u32 s68, 32, s49
    s_mul_i32 s67, s54, 145
    s_sub_u32 s66, s66, s67
    s_add_u32 s67, s66, s50
    s_sub_u32 s67, 8, s67
    s_mul_i32 s68, s54, 5
    s_sub_u32 s66, s66, s68
    s_add_u32 s66, s66, s69
    s_sub_u32 s66, s66, s50
    s_add_u32 s66, s66, 34
    s_cmp_lt_u32 s50, s69
    s_cmov_b32 s66, s67
    s_mov_b32 s68, 35840
    s_mul_i32 s67, s53, 81
    s_add_u32 s66, s66, s67
    s_lshl_b32 s66, s66, 10
    s_cmp_lt_u32 s50, s69
    s_subb_u32 s49, s49, 0
    s_lshl_b32 s69, s53, 22
    s_add_u32 s69, s69, 0x300000
    s_mov_b32 s67, 0xfffff
    s_lshl3_add_u32 s48, s53, s54
    v_lshlrev_b32 v9, 4, v0
    s_waitcnt lgkmcnt(0)
    s_load_dword s52, s[30:31], 0
    s_cmp_ge_u32 s3, 7
    s_cselect_b32 s64, s8, s6
    s_cselect_b32 s65, s9, s7
    s_add_u32 s40, s64, s69
    s_addc_u32 s41, s65, 0
    s_mov_b32 s42, 1048576
    s_mov_b32 s43, 0x20000
    s_mov_b32 s32, s30
    s_mov_b32 s33, s31
    s_mov_b32 s34, 660736
    s_mov_b32 s35, 0x20000
    s_barrier
    s_cmp_ge_u32 s54, 4
    s_cselect_b32 s69, 0, 0
    s_cselect_b32 s70, 1, 1
    s_cmp_lt_u32 s3, 6
    s_cbranch_scc1 L_go
    s_cmp_eq_u32 s3, 6
    s_cbranch_scc0 L_vw
    s_lshl_b32 s64, s48, 8
    s_add_u32 s64, s64, 236800
    v_mov_b64 v[10:11], -1
    v_mov_b64 v[12:13], -1
    s_mov_b64 exec, 0xffff
    buffer_store_dwordx4 v[10:13], v9, s[32:35], s64 offen sc1
    s_mov_b64 exec, -1
    s_branch L_go
L_vw:
    v_mov_b64 v[40:41], 0
    v_mov_b64 v[42:43], 0
    v_mov_b64 v[44:45], 0
    v_mov_b64 v[46:47], 0
    v_mov_b64 v[48:49], 0
    v_mov_b64 v[50:51], 0
W_5:
    ds_read_b32 v7, v6 offset:28
    s_waitcnt lgkmcnt(0)
    v_readfirstlane_b32 s98, v7
    s_cmp_ge_u32 s98, 5
    s_nop 2
    s_cbranch_scc1 WD_6
    s_sleep 1
    s_sub_u32 s99, s99, 1
    s_cbranch_scc0 W_5
    s_mov_b32 s99, 0
WD_6:
    s_lshl_b32 s96, s50, 2
    v_mov_b32 v38, s96
    s_mov_b64 vcc, 0
    s_mov_b32 s69, s70
L_go:
    s_cmp_eq_u32 s69, 1
    s_cbranch_scc1 L_iss2603
    s_cmp_eq_u32 s49, 3
    s_cbranch_scc1 L_is4_3
    s_and_b32 s66, s66, s67
    buffer_load_dwordx4 v[48:51], v9, s[40:43], s66 offen nt
    s_add_u32 s66, s66, s68
L_is4_3:
    s_and_b32 s66, s66, s67
    buffer_load_dwordx4 v[52:55], v9, s[40:43], s66 offen nt
    s_add_u32 s66, s66, s68
    s_and_b32 s66, s66, s67
    buffer_load_dwordx4 v[56:59], v9, s[40:43], s66 offen nt
    s_add_u32 s66, s66, s68
    s_and_b32 s66, s66, s67
    buffer_load_dwordx4 v[60:63], v9, s[40:43], s66 offen nt
    s_add_u32 s66, s66, s68
    s_and_b32 s66, s66, s67
    buffer_load_dwordx4 v[64:67], v9, s[40:43], s66 offen nt
    s_add_u32 s66, s66, s68
    s_waitcnt vmcnt(4)
    s_and_b32 s66, s66, s67
    buffer_load_dwordx4 v[68:71], v9, s[40:43], s66 offen nt
    s_add_u32 s66, s66, s68
    s_waitcnt vmcnt(4)
    s_and_b32 s66, s66, s67
    buffer_load_dwordx4 v[72:75], v9, s[40:43], s66 offen nt
    s_add_u32 s66, s66, s68
    s_waitcnt vmcnt(4)
    s_and_b32 s66, s66, s67
    buffer_load_dwordx4 v[76:79], v9, s[40:43], s66 offen nt
    s_add_u32 s66, s66, s68
    s_waitcnt vmcnt(4)
    s_and_b32 s66, s66, s67
    buffer_load_dwordx4 v[80:83], v9, s[40:43], s66 offen nt
    s_add_u32 s66, s66, s68
    s_waitcnt vmcnt(4)
    s_and_b32 s66, s66, s67
    buffer_load_dwordx4 v[84:87], v9, s[40:43], s66 offen nt
    s_add_u32 s66, s66, s68
    s_waitcnt vmcnt(4)
    s_and_b32 s66, s66, s67
    buffer_load_dwordx4 v[88:91], v9, s[40:43], s66 offen nt
    s_add_u32 s66, s66, s68
    s_waitcnt vmcnt(4)
    s_and_b32 s66, s66, s67
    buffer_load_dwordx4 v[92:95], v9, s[40:43], s66 offen nt
    s_add_u32 s66, s66, s68
    s_waitcnt vmcnt(4)
    s_and_b32 s66, s66, s67
    buffer_load_dwordx4 v[96:99], v9, s[40:43], s66 offen nt
    s_add_u32 s66, s66, s68
    s_waitcnt vmcnt(4)
    s_and_b32 s66, s66, s67
    buffer_load_dwordx4 v[100:103], v9, s[40:43], s66 offen nt
    s_add_u32 s66, s66, s68
    s_waitcnt vmcnt(4)
    s_and_b32 s66, s66, s67
    buffer_load_dwordx4 v[104:107], v9, s[40:43], s66 offen nt
    s_add_u32 s66, s66, s68
    s_waitcnt vmcnt(4)
    s_and_b32 s66, s66, s67
    buffer_load_dwordx4 v[108:111], v9, s[40:43], s66 offen nt
    s_add_u32 s66, s66, s68
    s_waitcnt vmcnt(4)
    s_and_b32 s66, s66, s67
    buffer_load_dwordx4 v[112:115], v9, s[40:43], s66 offen nt
    s_add_u32 s66, s66, s68
    s_waitcnt vmcnt(4)
    s_and_b32 s66, s66, s67
    buffer_load_dwordx4 v[116:119], v9, s[40:43], s66 offen nt
    s_add_u32 s66, s66, s68
    s_waitcnt vmcnt(4)
    s_and_b32 s66, s66, s67
    buffer_load_dwordx4 v[120:123], v9, s[40:43], s66 offen nt
    s_add_u32 s66, s66, s68
    s_waitcnt vmcnt(4)
    s_and_b32 s66, s66, s67
    buffer_load_dwordx4 v[124:127], v9, s[40:43], s66 offen nt
    s_add_u32 s66, s66, s68
    s_waitcnt vmcnt(4)
    s_and_b32 s66, s66, s67
    buffer_load_dwordx4 v[128:131], v9, s[40:43], s66 offen nt
    s_add_u32 s66, s66, s68
    s_waitcnt vmcnt(4)
    s_and_b32 s66, s66, s67
    buffer_load_dwordx4 v[132:135], v9, s[40:43], s66 offen nt
    s_add_u32 s66, s66, s68
    s_waitcnt vmcnt(4)
    s_and_b32 s66, s66, s67
    buffer_load_dwordx4 v[136:139], v9, s[40:43], s66 offen nt
    s_add_u32 s66, s66, s68
    s_waitcnt vmcnt(4)
    s_and_b32 s66, s66, s67
    buffer_load_dwordx4 v[140:143], v9, s[40:43], s66 offen nt
    s_add_u32 s66, s66, s68
    s_waitcnt vmcnt(4)
    s_and_b32 s66, s66, s67
    buffer_load_dwordx4 v[144:147], v9, s[40:43], s66 offen nt
    s_add_u32 s66, s66, s68
    s_waitcnt vmcnt(4)
    s_and_b32 s66, s66, s67
    buffer_load_dwordx4 v[148:151], v9, s[40:43], s66 offen nt
    s_add_u32 s66, s66, s68
    s_waitcnt vmcnt(4)
    s_and_b32 s66, s66, s67
    buffer_load_dwordx4 v[152:155], v9, s[40:43], s66 offen nt
    s_add_u32 s66, s66, s68
    s_waitcnt vmcnt(4)
    s_and_b32 s66, s66, s67
    buffer_load_dwordx4 v[156:159], v9, s[40:43], s66 offen nt
    s_add_u32 s66, s66, s68
    s_waitcnt vmcnt(4)
    s_and_b32 s66, s66, s67
    buffer_load_dwordx4 v[160:163], v9, s[40:43], s66 offen nt
    s_add_u32 s66, s66, s68
    s_waitcnt vmcnt(4)
    s_and_b32 s66, s66, s67
    buffer_load_dwordx4 v[164:167], v9, s[40:43], s66 offen nt
    s_branch L_issd
L_iss2603:
    s_cmp_eq_u32 s49, 3
    s_cbranch_scc1 L_is2603_3
    s_and_b32 s66, s66, s67
    buffer_load_dwordx4 v[48:51], v9, s[40:43], s66 offen nt
    s_add_u32 s66, s66, s68
L_is2603_3:
    s_and_b32 s66, s66, s67
    buffer_load_dwordx4 v[52:55], v9, s[40:43], s66 offen nt
    s_add_u32 s66, s66, s68
    s_and_b32 s66, s66, s67
    buffer_load_dwordx4 v[56:59], v9, s[40:43], s66 offen nt
    s_add_u32 s66, s66, s68
    s_and_b32 s66, s66, s67
    buffer_load_dwordx4 v[60:63], v9, s[40:43], s66 offen nt
    s_add_u32 s66, s66, s68
    s_waitcnt vmcnt(3)
    s_and_b32 s66, s66, s67
    buffer_load_dwordx4 v[64:67], v9, s[40:43], s66 offen nt
    s_add_u32 s66, s66, s68
    s_waitcnt vmcnt(3)
    s_and_b32 s66, s66, s67
    buffer_load_dwordx4 v[68:71], v9, s[40:43], s66 offen nt
    s_add_u32 s66, s66, s68
    s_waitcnt vmcnt(3)
    s_and_b32 s66, s66, s67
    buffer_load_dwordx4 v[72:75], v9, s[40:43], s66 offen nt
    s_add_u32 s66, s66, s68
    s_waitcnt vmcnt(3)
    s_and_b32 s66, s66, s67
    buffer_load_dwordx4 v[76:79], v9, s[40:43], s66 offen nt
    s_add_u32 s66, s66, s68
    s_waitcnt vmcnt(3)
    s_and_b32 s66, s66, s67
    buffer_load_dwordx4 v[80:83], v9, s[40:43], s66 offen nt
    s_add_u32 s66, s66, s68
    s_waitcnt vmcnt(3)
    s_and_b32 s66, s66, s67
    buffer_load_dwordx4 v[84:87], v9, s[40:43], s66 offen nt
    s_add_u32 s66, s66, s68
    s_waitcnt vmcnt(3)
    s_and_b32 s66, s66, s67
    buffer_load_dwordx4 v[88:91], v9, s[40:43], s66 offen nt
    s_add_u32 s66, s66, s68
    s_cbranch_vccnz U_7
    ds_read_b32 v7, v6 offset:20
    s_waitcnt vmcnt(3) lgkmcnt(0)
    v_cmp_le_u32 vcc, 5, v7
    s_nop 1
U_7:
    s_and_b32 s66, s66, s67
    buffer_load_dwordx4 v[92:95], v9, s[40:43], s66 offen nt
    s_add_u32 s66, s66, s68
    s_cbranch_vccnz U_8
    ds_read_b32 v7, v6 offset:20
    s_waitcnt vmcnt(3) lgkmcnt(0)
    v_cmp_le_u32 vcc, 5, v7
    s_nop 1
U_8:
    s_and_b32 s66, s66, s67
    buffer_load_dwordx4 v[96:99], v9, s[40:43], s66 offen nt
    s_add_u32 s66, s66, s68
    s_cbranch_vccnz U_9
    ds_read_b32 v7, v6 offset:20
    s_waitcnt vmcnt(3) lgkmcnt(0)
    v_cmp_le_u32 vcc, 5, v7
    s_nop 1
U_9:
    s_and_b32 s66, s66, s67
    buffer_load_dwordx4 v[100:103], v9, s[40:43], s66 offen nt
    s_add_u32 s66, s66, s68
    s_cbranch_vccnz U_10
    ds_read_b32 v7, v6 offset:20
    s_waitcnt vmcnt(3) lgkmcnt(0)
    v_cmp_le_u32 vcc, 5, v7
    s_nop 1
U_10:
    s_and_b32 s66, s66, s67
    buffer_load_dwordx4 v[104:107], v9, s[40:43], s66 offen nt
    s_add_u32 s66, s66, s68
    s_cbranch_vccnz U_11
    ds_read_b32 v7, v6 offset:20
    s_waitcnt vmcnt(3) lgkmcnt(0)
    v_cmp_le_u32 vcc, 5, v7
    s_nop 1
U_11:
    s_and_b32 s66, s66, s67
    buffer_load_dwordx4 v[108:111], v9, s[40:43], s66 offen nt
    s_add_u32 s66, s66, s68
    s_cbranch_vccnz U_12
    ds_read_b32 v7, v6 offset:20
    s_waitcnt vmcnt(3) lgkmcnt(0)
    v_cmp_le_u32 vcc, 5, v7
    s_nop 1
U_12:
    s_and_b32 s66, s66, s67
    buffer_load_dwordx4 v[112:115], v9, s[40:43], s66 offen nt
    s_add_u32 s66, s66, s68
    s_cbranch_vccnz U_13
    ds_read_b32 v7, v6 offset:20
    s_waitcnt vmcnt(3) lgkmcnt(0)
    v_cmp_le_u32 vcc, 5, v7
    s_nop 1
U_13:
    s_and_b32 s66, s66, s67
    buffer_load_dwordx4 v[116:119], v9, s[40:43], s66 offen nt
    s_add_u32 s66, s66, s68
    s_cbranch_vccnz U_14
    ds_read_b32 v7, v6 offset:20
    s_waitcnt vmcnt(3) lgkmcnt(0)
    v_cmp_le_u32 vcc, 5, v7
    s_nop 1
U_14:
    s_and_b32 s66, s66, s67
    buffer_load_dwordx4 v[120:123], v9, s[40:43], s66 offen nt
    s_add_u32 s66, s66, s68
    s_cbranch_vccnz U_15
    ds_read_b32 v7, v6 offset:20
    s_waitcnt vmcnt(3) lgkmcnt(0)
    v_cmp_le_u32 vcc, 5, v7
    s_nop 1
U_15:
    s_and_b32 s66, s66, s67
    buffer_load_dwordx4 v[124:127], v9, s[40:43], s66 offen nt
    s_add_u32 s66, s66, s68
    s_cbranch_vccnz U_16
    ds_read_b32 v7, v6 offset:20
    s_waitcnt vmcnt(3) lgkmcnt(0)
    v_cmp_le_u32 vcc, 5, v7
    s_nop 1
U_16:
    s_and_b32 s66, s66, s67
    buffer_load_dwordx4 v[128:131], v9, s[40:43], s66 offen nt
    s_add_u32 s66, s66, s68
    s_cbranch_vccnz U_17
    ds_read_b32 v7, v6 offset:20
    s_waitcnt vmcnt(3) lgkmcnt(0)
    v_cmp_le_u32 vcc, 5, v7
    s_nop 1
U_17:
    s_and_b32 s66, s66, s67
    buffer_load_dwordx4 v[132:135], v9, s[40:43], s66 offen nt
    s_add_u32 s66, s66, s68
    s_cbranch_vccnz U_18
    ds_read_b32 v7, v6 offset:20
    s_waitcnt vmcnt(3) lgkmcnt(0)
    v_cmp_le_u32 vcc, 5, v7
    s_nop 1
U_18:
    s_and_b32 s66, s66, s67
    buffer_load_dwordx4 v[136:139], v9, s[40:43], s66 offen nt
    s_add_u32 s66, s66, s68
    s_cbranch_vccnz U_19
    ds_read_b32 v7, v6 offset:20
    s_waitcnt vmcnt(3) lgkmcnt(0)
    v_cmp_le_u32 vcc, 5, v7
    s_nop 1
U_19:
    s_and_b32 s66, s66, s67
    buffer_load_dwordx4 v[140:143], v9, s[40:43], s66 offen nt
    s_add_u32 s66, s66, s68
    s_cbranch_vccnz U_20
    ds_read_b32 v7, v6 offset:20
    s_waitcnt vmcnt(3) lgkmcnt(0)
    v_cmp_le_u32 vcc, 5, v7
    s_nop 1
U_20:
    s_and_b32 s66, s66, s67
    buffer_load_dwordx4 v[144:147], v9, s[40:43], s66 offen nt
    s_add_u32 s66, s66, s68
    s_and_b32 s66, s66, s67
    buffer_load_dwordx4 v[148:151], v9, s[40:43], s66 offen nt
    s_add_u32 s66, s66, s68
    s_and_b32 s66, s66, s67
    buffer_load_dwordx4 v[152:155], v9, s[40:43], s66 offen nt
    s_add_u32 s66, s66, s68
    s_and_b32 s66, s66, s67
    buffer_load_dwordx4 v[156:159], v9, s[40:43], s66 offen nt
    s_add_u32 s66, s66, s68
    s_and_b32 s66, s66, s67
    buffer_load_dwordx4 v[160:163], v9, s[40:43], s66 offen nt
    s_add_u32 s66, s66, s68
    s_and_b32 s66, s66, s67
    buffer_load_dwordx4 v[164:167], v9, s[40:43], s66 offen nt
L_issd:
    s_mov_b64 exec, 1
    v_mov_b32 v8, 1
    ds_add_u32 v6, v8 offset:28
    s_mov_b64 exec, -1
    s_waitcnt lgkmcnt(0)
    s_mul_i32 s52, s52, 0x5bd1e9c5
    s_add_u32 s52, s52, 0x6a09e6b7
    s_cmp_ge_u32 s3, 7
    s_cbranch_scc1 L_v
    s_setprio 2
    s_lshl_b32 s96, s53, 12
    s_lshl_b32 s97, s50, 8
    s_add_u32 s96, s96, s97
    s_add_u32 s64, s96, 86016
    s_lshl_b32 s97, s50, 6
    v_and_b32 v9, 15, v0
    v_lshl_add_u32 v19, v9, 2, s97
    v_lshrrev_b32 v14, 5, v0
    v_lshl_add_u32 v19, v14, 1, v19
    v_lshrrev_b32 v14, 4, v0
    v_lshlrev_b32 v14, 10, v14
    v_lshl_add_u32 v14, v9, 4, v14
    v_lshlrev_b32 v9, 4, v9
    v_and_b32 v16, 3, v0
    v_lshlrev_b32 v16, 2, v16
    v_bfe_u32 v17, v0, 2, 1
    v_lshl_add_u32 v16, v17, 1, v16
    v_bfe_u32 v17, v0, 3, 1
    v_add_u32 v16, v16, v17
    v_cmp_gt_u32 s[76:77], s49, v16
    v_lshrrev_b32 v18, 4, v0
    v_lshlrev_b32 v18, 6, v18
    s_lshl_b32 s96, s50, 8
    s_add_u32 s96, s96, 4352
    v_add_u32 v18, s96, v18
    v_lshl_add_u32 v16, v16, 1, v18
    s_cmp_eq_u32 s50, 4
    s_cbranch_scc1 L_k4
P_21:
    buffer_load_dwordx4 v[10:13], v14, s[32:35], s64 offen sc1
    s_waitcnt vmcnt(0)
    v_cmp_ne_u32 vcc, s52, v11
    v_cmp_ne_u32 s[96:97], s52, v13
    s_or_b64 vcc, vcc, s[96:97]
    s_cmp_eq_u64 vcc, 0
    s_nop 1
    s_cbranch_scc1 PD_22
    s_sub_u32 s99, s99, 16
    s_cbranch_scc0 P_21
    s_mov_b32 s99, 0
PD_22:
    v_permlane32_swap_b32 v10, v12
    v_add_f32 v10, v10, v12
    v_mov_b32 v11, v10
    s_nop 1
    v_permlane16_swap_b32 v10, v11
    v_add_f32 v10, v10, v11
    v_cvt_pk_bf16_f32 v10, v10, v10
    ds_write_b16 v19, v10 offset:4096
    s_mov_b64 exec, 1
    v_mov_b32 v8, 1
    ds_add_u32 v6, v8 offset:12
    s_mov_b64 exec, -1
L_k4:
    v_and_b32 v18, 3, v0
    v_cmp_eq_u32 s[70:71], 1, v18
    v_cmp_eq_u32 s[72:73], 2, v18
    v_cmp_eq_u32 s[74:75], 3, v18
    s_lshl_b32 s96, s50, 2
    v_mov_b32 v24, s96
    v_mov_b32 v8, 1
    v_mov_b32 v17, 0xff800000
W_23:
    ds_read_b32 v7, v6 offset:12
    s_waitcnt lgkmcnt(0)
    v_readfirstlane_b32 s98, v7
    s_cmp_ge_u32 s98, 4
    s_nop 2
    s_cbranch_scc1 WD_24
    s_sleep 1
    s_sub_u32 s99, s99, 1
    s_cbranch_scc0 W_23
    s_mov_b32 s99, 0
WD_24:
    ds_read_b128 v[10:13], v9 offset:4096
    s_waitcnt lgkmcnt(0)
    s_waitcnt vmcnt(28)
    v_dot2_f32_bf16 v40, v40, v10, 0
    v_dot2_f32_bf16 v44, v44, v10, 0
    v_dot2_f32_bf16 v48, v48, v10, 0
    v_dot2_f32_bf16 v52, v52, v10, 0
    v_dot2_f32_bf16 v40, v41, v11, v40
    v_dot2_f32_bf16 v44, v45, v11, v44
    v_dot2_f32_bf16 v48, v49, v11, v48
    v_dot2_f32_bf16 v52, v53, v11, v52
    v_dot2_f32_bf16 v40, v42, v12, v40
    v_dot2_f32_bf16 v44, v46, v12, v44
    v_dot2_f32_bf16 v48, v50, v12, v48
    v_dot2_f32_bf16 v52, v54, v12, v52
    v_dot2_f32_bf16 v40, v43, v13, v40
    v_dot2_f32_bf16 v44, v47, v13, v44
    v_dot2_f32_bf16 v48, v51, v13, v48
    v_dot2_f32_bf16 v52, v55, v13, v52
    s_waitcnt vmcnt(24)
    v_dot2_f32_bf16 v56, v56, v10, 0
    v_dot2_f32_bf16 v60, v60, v10, 0
    v_dot2_f32_bf16 v64, v64, v10, 0
    v_dot2_f32_bf16 v68, v68, v10, 0
    v_dot2_f32_bf16 v56, v57, v11, v56
    v_dot2_f32_bf16 v60, v61, v11, v60
    v_dot2_f32_bf16 v64, v65, v11, v64
    v_dot2_f32_bf16 v68, v69, v11, v68
    v_dot2_f32_bf16 v56, v58, v12, v56
    v_dot2_f32_bf16 v60, v62, v12, v60
    v_dot2_f32_bf16 v64, v66, v12, v64
    v_dot2_f32_bf16 v68, v70, v12, v68
    v_dot2_f32_bf16 v56, v59, v13, v56
    v_dot2_f32_bf16 v60, v63, v13, v60
    v_dot2_f32_bf16 v64, v67, v13, v64
    v_dot2_f32_bf16 v68, v71, v13, v68
    s_waitcnt vmcnt(20)
    v_dot2_f32_bf16 v72, v72, v10, 0
    v_dot2_f32_bf16 v76, v76, v10, 0
    v_dot2_f32_bf16 v80, v80, v10, 0
    v_dot2_f32_bf16 v84, v84, v10, 0
    v_dot2_f32_bf16 v72, v73, v11, v72
    v_dot2_f32_bf16 v76, v77, v11, v76
    v_dot2_f32_bf16 v80, v81, v11, v80
    v_dot2_f32_bf16 v84, v85, v11, v84
    v_dot2_f32_bf16 v72, v74, v12, v72
    v_dot2_f32_bf16 v76, v78, v12, v76
    v_dot2_f32_bf16 v80, v82, v12, v80
    v_dot2_f32_bf16 v84, v86, v12, v84
    v_dot2_f32_bf16 v72, v75, v13, v72
    v_dot2_f32_bf16 v76, v79, v13, v76
    v_dot2_f32_bf16 v80, v83, v13, v80
    v_dot2_f32_bf16 v84, v87, v13, v84
    s_waitcnt vmcnt(16)
    v_dot2_f32_bf16 v88, v88, v10, 0
    v_dot2_f32_bf16 v92, v92, v10, 0
    v_dot2_f32_bf16 v96, v96, v10, 0
    v_dot2_f32_bf16 v100, v100, v10, 0
    v_dot2_f32_bf16 v88, v89, v11, v88
    v_dot2_f32_bf16 v92, v93, v11, v92
    v_dot2_f32_bf16 v96, v97, v11, v96
    v_dot2_f32_bf16 v100, v101, v11, v100
    v_dot2_f32_bf16 v88, v90, v12, v88
    v_dot2_f32_bf16 v92, v94, v12, v92
    v_dot2_f32_bf16 v96, v98, v12, v96
    v_dot2_f32_bf16 v100, v102, v12, v100
    v_dot2_f32_bf16 v88, v91, v13, v88
    v_dot2_f32_bf16 v92, v95, v13, v92
    v_dot2_f32_bf16 v96, v99, v13, v96
    v_dot2_f32_bf16 v100, v103, v13, v100
    s_waitcnt vmcnt(12)
    v_dot2_f32_bf16 v104, v104, v10, 0
    v_dot2_f32_bf16 v108, v108, v10, 0
    v_dot2_f32_bf16 v112, v112, v10, 0
    v_dot2_f32_bf16 v116, v116, v10, 0
    v_dot2_f32_bf16 v104, v105, v11, v104
    v_dot2_f32_bf16 v108, v109, v11, v108
    v_dot2_f32_bf16 v112, v113, v11, v112
    v_dot2_f32_bf16 v116, v117, v11, v116
    v_dot2_f32_bf16 v104, v106, v12, v104
    v_dot2_f32_bf16 v108, v110, v12, v108
    v_dot2_f32_bf16 v112, v114, v12, v112
    v_dot2_f32_bf16 v116, v118, v12, v116
    v_dot2_f32_bf16 v104, v107, v13, v104
    v_dot2_f32_bf16 v108, v111, v13, v108
    v_dot2_f32_bf16 v112, v115, v13, v112
    v_dot2_f32_bf16 v116, v119, v13, v116
    s_waitcnt vmcnt(8)
    v_dot2_f32_bf16 v120, v120, v10, 0
    v_dot2_f32_bf16 v124, v124, v10, 0
    v_dot2_f32_bf16 v128, v128, v10, 0
    v_dot2_f32_bf16 v132, v132, v10, 0
    v_dot2_f32_bf16 v120, v121, v11, v120
    v_dot2_f32_bf16 v124, v125, v11, v124
    v_dot2_f32_bf16 v128, v129, v11, v128
    v_dot2_f32_bf16 v132, v133, v11, v132
    v_dot2_f32_bf16 v120, v122, v12, v120
    v_dot2_f32_bf16 v124, v126, v12, v124
    v_dot2_f32_bf16 v128, v130, v12, v128
    v_dot2_f32_bf16 v132, v134, v12, v132
    v_dot2_f32_bf16 v120, v123, v13, v120
    v_dot2_f32_bf16 v124, v127, v13, v124
    v_dot2_f32_bf16 v128, v131, v13, v128
    v_dot2_f32_bf16 v132, v135, v13, v132
    s_waitcnt vmcnt(4)
    v_dot2_f32_bf16 v136, v136, v10, 0
    v_dot2_f32_bf16 v140, v140, v10, 0
    v_dot2_f32_bf16 v144, v144, v10, 0
    v_dot2_f32_bf16 v148, v148, v10, 0
    v_dot2_f32_bf16 v136, v137, v11, v136
    v_dot2_f32_bf16 v140, v141, v11, v140
    v_dot2_f32_bf16 v144, v145, v11, v144
    v_dot2_f32_bf16 v148, v149, v11, v148
    v_dot2_f32_bf16 v136, v138, v12, v136
    v_dot2_f32_bf16 v140, v142, v12, v140
    v_dot2_f32_bf16 v144, v146, v12, v144
    v_dot2_f32_bf16 v148, v150, v12, v148
    v_dot2_f32_bf16 v136, v139, v13, v136
    v_dot2_f32_bf16 v140, v143, v13, v140
    v_dot2_f32_bf16 v144, v147, v13, v144
    v_dot2_f32_bf16 v148, v151, v13, v148
    s_waitcnt vmcnt(0)
    v_dot2_f32_bf16 v152, v152, v10, 0
    v_dot2_f32_bf16 v156, v156, v10, 0
    v_dot2_f32_bf16 v160, v160, v10, 0
    v_dot2_f32_bf16 v164, v164, v10, 0
    v_dot2_f32_bf16 v152, v153, v11, v152
    v_dot2_f32_bf16 v156, v157, v11, v156
    v_dot2_f32_bf16 v160, v161, v11, v160
    v_dot2_f32_bf16 v164, v165, v11, v164
    v_dot2_f32_bf16 v152, v154, v12, v152
    v_dot2_f32_bf16 v156, v158, v12, v156
    v_dot2_f32_bf16 v160, v162, v12, v160
    v_dot2_f32_bf16 v164, v166, v12, v164
    v_dot2_f32_bf16 v152, v155, v13, v152
    v_dot2_f32_bf16 v156, v159, v13, v156
    v_dot2_f32_bf16 v160, v163, v13, v160
    v_dot2_f32_bf16 v164, v167, v13, v164
    v_add_f32_dpp v40, v40, v40 row_ror:8 row_mask:0xf bank_mask:0xf
    v_add_f32_dpp v48, v48, v48 row_ror:8 row_mask:0xf bank_mask:0xf
    v_add_f32_dpp v56, v56, v56 row_ror:8 row_mask:0xf bank_mask:0xf
    v_add_f32_dpp v64, v64, v64 row_ror:8 row_mask:0xf bank_mask:0xf
    v_add_f32_dpp v72, v72, v72 row_ror:8 row_mask:0xf bank_mask:0xf
    v_add_f32_dpp v80, v80, v80 row_ror:8 row_mask:0xf bank_mask:0xf
    v_add_f32_dpp v88, v88, v88 row_ror:8 row_mask:0xf bank_mask:0xf
    v_add_f32_dpp v96, v96, v96 row_ror:8 row_mask:0xf bank_mask:0xf
    v_add_f32_dpp v104, v104, v104 row_ror:8 row_mask:0xf bank_mask:0xf
    v_add_f32_dpp v112, v112, v112 row_ror:8 row_mask:0xf bank_mask:0xf
    v_add_f32_dpp v120, v120, v120 row_ror:8 row_mask:0xf bank_mask:0xf
    v_add_f32_dpp v128, v128, v128 row_ror:8 row_mask:0xf bank_mask:0xf
    v_add_f32_dpp v136, v136, v136 row_ror:8 row_mask:0xf bank_mask:0xf
    v_add_f32_dpp v144, v144, v144 row_ror:8 row_mask:0xf bank_mask:0xf
    v_add_f32_dpp v152, v152, v152 row_ror:8 row_mask:0xf bank_mask:0xf
    v_add_f32_dpp v160, v160, v160 row_ror:8 row_mask:0xf bank_mask:0xf
    v_add_f32_dpp v40, v44, v44 row_ror:8 row_mask:0xf bank_mask:0xc
    v_add_f32_dpp v48, v52, v52 row_ror:8 row_mask:0xf bank_mask:0xc
    v_add_f32_dpp v56, v60, v60 row_ror:8 row_mask:0xf bank_mask:0xc
    v_add_f32_dpp v64, v68, v68 row_ror:8 row_mask:0xf bank_mask:0xc
    v_add_f32_dpp v72, v76, v76 row_ror:8 row_mask:0xf bank_mask:0xc
    v_add_f32_dpp v80, v84, v84 row_ror:8 row_mask:0xf bank_mask:0xc
    v_add_f32_dpp v88, v92, v92 row_ror:8 row_mask:0xf bank_mask:0xc
    v_add_f32_dpp v96, v100, v100 row_ror:8 row_mask:0xf bank_mask:0xc
    v_add_f32_dpp v104, v108, v108 row_ror:8 row_mask:0xf bank_mask:0xc
    v_add_f32_dpp v112, v116, v116 row_ror:8 row_mask:0xf bank_mask:0xc
    v_add_f32_dpp v120, v124, v124 row_ror:8 row_mask:0xf bank_mask:0xc
    v_add_f32_dpp v128, v132, v132 row_ror:8 row_mask:0xf bank_mask:0xc
    v_add_f32_dpp v136, v140, v140 row_ror:8 row_mask:0xf bank_mask:0xc
    v_add_f32_dpp v144, v148, v148 row_ror:8 row_mask:0xf bank_mask:0xc
    v_add_f32_dpp v152, v156, v156 row_ror:8 row_mask:0xf bank_mask:0xc
    v_add_f32_dpp v160, v164, v164 row_ror:8 row_mask:0xf bank_mask:0xc
    v_add_f32_dpp v40, v40, v40 row_half_mirror row_mask:0xf bank_mask:0xf
    v_add_f32_dpp v56, v56, v56 row_half_mirror row_mask:0xf bank_mask:0xf
    v_add_f32_dpp v72, v72, v72 row_half_mirror row_mask:0xf bank_mask:0xf
    v_add_f32_dpp v88, v88, v88 row_half_mirror row_mask:0xf bank_mask:0xf
    v_add_f32_dpp v104, v104, v104 row_half_mirror row_mask:0xf bank_mask:0xf
    v_add_f32_dpp v120, v120, v120 row_half_mirror row_mask:0xf bank_mask:0xf
    v_add_f32_dpp v136, v136, v136 row_half_mirror row_mask:0xf bank_mask:0xf
    v_add_f32_dpp v152, v152, v152 row_half_mirror row_mask:0xf bank_mask:0xf
    v_add_f32_dpp v40, v48, v48 row_half_mirror row_mask:0xf bank_mask:0xa
    v_add_f32_dpp v56, v64, v64 row_half_mirror row_mask:0xf bank_mask:0xa
    v_add_f32_dpp v72, v80, v80 row_half_mirror row_mask:0xf bank_mask:0xa
    v_add_f32_dpp v88, v96, v96 row_half_mirror row_mask:0xf bank_mask:0xa
    v_add_f32_dpp v104, v112, v112 row_half_mirror row_mask:0xf bank_mask:0xa
    v_add_f32_dpp v120, v128, v128 row_half_mirror row_mask:0xf bank_mask:0xa
    v_add_f32_dpp v136, v144, v144 row_half_mirror row_mask:0xf bank_mask:0xa
    v_add_f32_dpp v152, v160, v160 row_half_mirror row_mask:0xf bank_mask:0xa
    v_add_f32_dpp v40, v40, v40 quad_perm:[1,0,3,2] row_mask:0xf bank_mask:0xf
    v_add_f32_dpp v56, v56, v56 quad_perm:[1,0,3,2] row_mask:0xf bank_mask:0xf
    v_add_f32_dpp v72, v72, v72 quad_perm:[1,0,3,2] row_mask:0xf bank_mask:0xf
    v_add_f32_dpp v88, v88, v88 quad_perm:[1,0,3,2] row_mask:0xf bank_mask:0xf
    v_add_f32_dpp v104, v104, v104 quad_perm:[1,0,3,2] row_mask:0xf bank_mask:0xf
    v_add_f32_dpp v120, v120, v120 quad_perm:[1,0,3,2] row_mask:0xf bank_mask:0xf
    v_add_f32_dpp v136, v136, v136 quad_perm:[1,0,3,2] row_mask:0xf bank_mask:0xf
    v_add_f32_dpp v152, v152, v152 quad_perm:[1,0,3,2] row_mask:0xf bank_mask:0xf
    v_add_f32_dpp v40, v40, v40 quad_perm:[2,3,0,1] row_mask:0xf bank_mask:0xf
    v_add_f32_dpp v56, v56, v56 quad_perm:[2,3,0,1] row_mask:0xf bank_mask:0xf
    v_add_f32_dpp v72, v72, v72 quad_perm:[2,3,0,1] row_mask:0xf bank_mask:0xf
    v_add_f32_dpp v88, v88, v88 quad_perm:[2,3,0,1] row_mask:0xf bank_mask:0xf
    v_add_f32_dpp v104, v104, v104 quad_perm:[2,3,0,1] row_mask:0xf bank_mask:0xf
    v_add_f32_dpp v120, v120, v120 quad_perm:[2,3,0,1] row_mask:0xf bank_mask:0xf
    v_add_f32_dpp v136, v136, v136 quad_perm:[2,3,0,1] row_mask:0xf bank_mask:0xf
    v_add_f32_dpp v152, v152, v152 quad_perm:[2,3,0,1] row_mask:0xf bank_mask:0xf
    v_cndmask_b32 v20, v40, v56, s[70:71]
    v_cndmask_b32 v21, v104, v120, s[70:71]
    v_cndmask_b32 v20, v20, v72, s[72:73]
    v_cndmask_b32 v21, v21, v136, s[72:73]
    v_cndmask_b32 v20, v20, v88, s[74:75]
    v_cndmask_b32 v21, v21, v152, s[74:75]
    v_cvt_pk_bf16_f32 v21, v20, v21
    v_lshlrev_b32 v20, 16, v21
    v_and_b32 v21, 0xffff0000, v21
    v_mul_f32 v20, 0x3db504f3, v20
    v_mul_f32 v21, 0x3db504f3, v21
    v_cvt_pk_bf16_f32 v21, v20, v21
    v_lshlrev_b32 v20, 16, v21
    v_and_b32 v21, 0xffff0000, v21
    v_cndmask_b32 v20, v20, v17, s[76:77]
    v_max_f32 v22, v20, v21
    s_nop 1
    v_max_f32_dpp v22, v22, v22 row_ror:8 row_mask:0xf bank_mask:0xf
    s_nop 1
    v_max_f32_dpp v22, v22, v22 row_ror:4 row_mask:0xf bank_mask:0xf
    s_nop 1
    v_max_f32_dpp v22, v22, v22 row_ror:2 row_mask:0xf bank_mask:0xf
    s_nop 1
    v_max_f32_dpp v22, v22, v22 row_ror:1 row_mask:0xf bank_mask:0xf
    v_mov_b32 v23, v22
    s_nop 1
    v_permlane16_swap_b32 v22, v23
    v_max_f32 v22, v22, v23
    v_mov_b32 v23, v22
    s_nop 1
    v_permlane32_swap_b32 v22, v23
    v_max_f32 v22, v22, v23
    s_mov_b64 exec, 1
    ds_write_b32 v24, v22 offset:80
    ds_add_u32 v6, v8 offset:16
    s_mov_b64 exec, -1
W_25:
    ds_read_b32 v7, v6 offset:16
    s_waitcnt lgkmcnt(0)
    v_readfirstlane_b32 s98, v7
    s_cmp_ge_u32 s98, 5
    s_nop 2
    s_cbranch_scc1 WD_26
    s_sleep 1
    s_sub_u32 s99, s99, 1
    s_cbranch_scc0 W_25
    s_mov_b32 s99, 0
WD_26:
    ds_read_b128 v[26:29], v6 offset:80
    ds_read_b32 v30, v6 offset:96
    s_waitcnt lgkmcnt(0)
    v_max3_f32 v32, v26, v27, v28
    v_max3_f32 v32, v32, v29, v30
    v_sub_f32 v20, v20, v32
    v_sub_f32 v21, v21, v32
    v_mul_f32 v20, 0x3fb8aa3b, v20
    v_mul_f32 v21, 0x3fb8aa3b, v21
    v_exp_f32 v20, v20
    v_exp_f32 v21, v21
    s_nop 0
    v_cvt_pk_bf16_f32 v22, v20, v21
    ds_write_b16 v16, v22
    ds_write_b16_d16_hi v16, v22 offset:32
    ds_write_b32 v24, v8 offset:32
    v_add_f32 v23, v20, v21
    s_nop 1
    v_add_f32_dpp v23, v23, v23 row_ror:8 row_mask:0xf bank_mask:0xf
    s_nop 1
    v_add_f32_dpp v23, v23, v23 row_ror:4 row_mask:0xf bank_mask:0xf
    s_nop 1
    v_add_f32_dpp v23, v23, v23 row_ror:2 row_mask:0xf bank_mask:0xf
    s_nop 1
    v_add_f32_dpp v23, v23, v23 row_ror:1 row_mask:0xf bank_mask:0xf
    v_mov_b32 v25, v23
    s_nop 1
    v_permlane16_swap_b32 v23, v25
    v_add_f32 v23, v23, v25
    v_mov_b32 v25, v23
    s_nop 1
    v_permlane32_swap_b32 v23, v25
    v_add_f32 v23, v23, v25
    v_mov_b32 v33, s52
    v_mov_b32 v35, s52
    s_lshl_b32 s96, s48, 4
    s_add_u32 s64, s96, 217088
    s_mov_b64 exec, 1
    ds_add_f32 v6, v23 offset:64
    s_mov_b64 exec, 1
    ds_add_rtn_u32 v7, v6, v8 offset:20
    ds_read_b32 v34, v6 offset:64
    s_waitcnt lgkmcnt(0)
    v_readfirstlane_b32 s98, v7
    s_cmp_lg_u32 s98, 4
    s_nop 2
    s_cbranch_scc1 L_fin
    buffer_store_dwordx4 v[32:35], v6, s[32:35], s64 offen sc1
    s_endpgm
L_v:
    v_and_b32 v8, 1, v0
    v_lshlrev_b32 v8, 4, v8
    v_lshlrev_b32_e64 v8, v8, 1
    v_bfe_u32 v7, v0, 1, 2
    v_cmp_eq_u32 vcc, 0, v7
    s_nop 1
    v_cndmask_b32 v2, 0, v8, vcc
    v_cmp_eq_u32 vcc, 1, v7
    s_nop 1
    v_cndmask_b32 v3, 0, v8, vcc
    v_cmp_eq_u32 vcc, 2, v7
    s_nop 1
    v_cndmask_b32 v4, 0, v8, vcc
    v_cmp_eq_u32 vcc, 3, v7
    s_nop 1
    v_cndmask_b32 v5, 0, v8, vcc
    s_lshl_b32 s96, s50, 2
    v_mov_b32 v9, s96
    v_lshrrev_b32 v38, 4, v0
    v_lshlrev_b32 v39, 6, v38
    s_lshl_b32 s96, s50, 8
    v_add_u32 v39, s96, v39
    v_lshlrev_b32 v38, 7, v38
    v_and_b32 v8, 7, v0
    v_lshl_add_u32 v38, v8, 4, v38
    s_lshl_b32 s96, s50, 9
    v_add_u32 v38, s96, v38
    s_lshl_b32 s64, s48, 8
    s_add_u32 s64, s64, 236800
W_27:
    ds_read_b32 v7, v9 offset:32
    s_waitcnt lgkmcnt(0)
    v_readfirstlane_b32 s98, v7
    s_cmp_ge_u32 s98, 1
    s_nop 2
    s_cbranch_scc1 WD_28
    s_sleep 1
    s_sub_u32 s99, s99, 1
    s_cbranch_scc0 W_27
    s_mov_b32 s99, 0
WD_28:
    s_setprio 2
    ds_read_b128 v[10:13], v39 offset:4352
    ds_read_b128 v[14:17], v39 offset:4368
    ds_read_b128 v[18:21], v39 offset:4384
    ds_read_b128 v[22:25], v39 offset:4400
    v_bfe_u32 v8, v0, 5, 1
    v_lshlrev_b32 v9, 8, v8
    v_bfe_u32 v8, v0, 1, 3
    v_lshl_add_u32 v9, v8, 5, v9
    v_bfe_u32 v8, v0, 4, 1
    v_lshl_add_u32 v9, v8, 4, v9
    v_bfe_u32 v8, v0, 0, 1
    v_lshl_add_u32 v9, v8, 3, v9
    v_mov_b32 v8, 1
    v_lshlrev_b32 v39, 2, v0
    s_mov_b32 s66, 0x11111111
    s_mov_b32 s67, s66
    s_waitcnt lgkmcnt(0)
    v_mul_u32_u24_sdwa v26, v11, v2 dst_sel:DWORD dst_unused:UNUSED_PAD src0_sel:WORD_0 src1_sel:DWORD
    v_mul_u32_u24_sdwa v27, v11, v3 dst_sel:DWORD dst_unused:UNUSED_PAD src0_sel:WORD_0 src1_sel:DWORD
    v_mul_u32_u24_sdwa v28, v11, v4 dst_sel:DWORD dst_unused:UNUSED_PAD src0_sel:WORD_0 src1_sel:DWORD
    v_mul_u32_u24_sdwa v29, v11, v5 dst_sel:DWORD dst_unused:UNUSED_PAD src0_sel:WORD_0 src1_sel:DWORD
    v_mul_u32_u24_sdwa v30, v11, v2 dst_sel:DWORD dst_unused:UNUSED_PAD src0_sel:WORD_1 src1_sel:DWORD
    v_mul_u32_u24_sdwa v31, v11, v3 dst_sel:DWORD dst_unused:UNUSED_PAD src0_sel:WORD_1 src1_sel:DWORD
    v_mul_u32_u24_sdwa v32, v11, v4 dst_sel:DWORD dst_unused:UNUSED_PAD src0_sel:WORD_1 src1_sel:DWORD
    v_mul_u32_u24_sdwa v33, v11, v5 dst_sel:DWORD dst_unused:UNUSED_PAD src0_sel:WORD_1 src1_sel:DWORD
    s_waitcnt vmcnt(29)
    v_mfma_f32_16x16x32_bf16 v[34:37], v[48:51], v[26:29], 0
    v_mul_u32_u24_sdwa v26, v12, v2 dst_sel:DWORD dst_unused:UNUSED_PAD src0_sel:WORD_0 src1_sel:DWORD
    v_mul_u32_u24_sdwa v27, v12, v3 dst_sel:DWORD dst_unused:UNUSED_PAD src0_sel:WORD_0 src1_sel:DWORD
    v_mul_u32_u24_sdwa v28, v12, v4 dst_sel:DWORD dst_unused:UNUSED_PAD src0_sel:WORD_0 src1_sel:DWORD
    v_mul_u32_u24_sdwa v29, v12, v5 dst_sel:DWORD dst_unused:UNUSED_PAD src0_sel:WORD_0 src1_sel:DWORD
    s_waitcnt vmcnt(28)
    v_mfma_f32_16x16x32_bf16 v[34:37], v[52:55], v[30:33], v[34:37]
    v_mul_u32_u24_sdwa v30, v12, v2 dst_sel:DWORD dst_unused:UNUSED_PAD src0_sel:WORD_1 src1_sel:DWORD
    v_mul_u32_u24_sdwa v31, v12, v3 dst_sel:DWORD dst_unused:UNUSED_PAD src0_sel:WORD_1 src1_sel:DWORD
    v_mul_u32_u24_sdwa v32, v12, v4 dst_sel:DWORD dst_unused:UNUSED_PAD src0_sel:WORD_1 src1_sel:DWORD
    v_mul_u32_u24_sdwa v33, v12, v5 dst_sel:DWORD dst_unused:UNUSED_PAD src0_sel:WORD_1 src1_sel:DWORD
    s_waitcnt vmcnt(27)
    v_mfma_f32_16x16x32_bf16 v[34:37], v[56:59], v[26:29], v[34:37]
    v_mul_u32_u24_sdwa v26, v13, v2 dst_sel:DWORD dst_unused:UNUSED_PAD src0_sel:WORD_0 src1_sel:DWORD
    v_mul_u32_u24_sdwa v27, v13, v3 dst_sel:DWORD dst_unused:UNUSED_PAD src0_sel:WORD_0 src1_sel:DWORD
    v_mul_u32_u24_sdwa v28, v13, v4 dst_sel:DWORD dst_unused:UNUSED_PAD src0_sel:WORD_0 src1_sel:DWORD
    v_mul_u32_u24_sdwa v29, v13, v5 dst_sel:DWORD dst_unused:UNUSED_PAD src0_sel:WORD_0 src1_sel:DWORD
    s_waitcnt vmcnt(26)
    v_mfma_f32_16x16x32_bf16 v[34:37], v[60:63], v[30:33], v[34:37]
    v_mul_u32_u24_sdwa v30, v13, v2 dst_sel:DWORD dst_unused:UNUSED_PAD src0_sel:WORD_1 src1_sel:DWORD
    v_mul_u32_u24_sdwa v31, v13, v3 dst_sel:DWORD dst_unused:UNUSED_PAD src0_sel:WORD_1 src1_sel:DWORD
    v_mul_u32_u24_sdwa v32, v13, v4 dst_sel:DWORD dst_unused:UNUSED_PAD src0_sel:WORD_1 src1_sel:DWORD
    v_mul_u32_u24_sdwa v33, v13, v5 dst_sel:DWORD dst_unused:UNUSED_PAD src0_sel:WORD_1 src1_sel:DWORD
    s_waitcnt vmcnt(25)
    v_mfma_f32_16x16x32_bf16 v[34:37], v[64:67], v[26:29], v[34:37]
    v_mul_u32_u24_sdwa v26, v14, v2 dst_sel:DWORD dst_unused:UNUSED_PAD src0_sel:WORD_0 src1_sel:DWORD
    v_mul_u32_u24_sdwa v27, v14, v3 dst_sel:DWORD dst_unused:UNUSED_PAD src0_sel:WORD_0 src1_sel:DWORD
    v_mul_u32_u24_sdwa v28, v14, v4 dst_sel:DWORD dst_unused:UNUSED_PAD src0_sel:WORD_0 src1_sel:DWORD
    v_mul_u32_u24_sdwa v29, v14, v5 dst_sel:DWORD dst_unused:UNUSED_PAD src0_sel:WORD_0 src1_sel:DWORD
    s_waitcnt vmcnt(24)
    v_mfma_f32_16x16x32_bf16 v[34:37], v[68:71], v[30:33], v[34:37]
    v_mul_u32_u24_sdwa v30, v14, v2 dst_sel:DWORD dst_unused:UNUSED_PAD src0_sel:WORD_1 src1_sel:DWORD
    v_mul_u32_u24_sdwa v31, v14, v3 dst_sel:DWORD dst_unused:UNUSED_PAD src0_sel:WORD_1 src1_sel:DWORD
    v_mul_u32_u24_sdwa v32, v14, v4 dst_sel:DWORD dst_unused:UNUSED_PAD src0_sel:WORD_1 src1_sel:DWORD
    v_mul_u32_u24_sdwa v33, v14, v5 dst_sel:DWORD dst_unused:UNUSED_PAD src0_sel:WORD_1 src1_sel:DWORD
    s_waitcnt vmcnt(23)
    v_mfma_f32_16x16x32_bf16 v[34:37], v[72:75], v[26:29], v[34:37]
    v_mul_u32_u24_sdwa v26, v15, v2 dst_sel:DWORD dst_unused:UNUSED_PAD src0_sel:WORD_0 src1_sel:DWORD
    v_mul_u32_u24_sdwa v27, v15, v3 dst_sel:DWORD dst_unused:UNUSED_PAD src0_sel:WORD_0 src1_sel:DWORD
    v_mul_u32_u24_sdwa v28, v15, v4 dst_sel:DWORD dst_unused:UNUSED_PAD src0_sel:WORD_0 src1_sel:DWORD
    v_mul_u32_u24_sdwa v29, v15, v5 dst_sel:DWORD dst_unused:UNUSED_PAD src0_sel:WORD_0 src1_sel:DWORD
    s_waitcnt vmcnt(22)
    v_mfma_f32_16x16x32_bf16 v[34:37], v[76:79], v[30:33], v[34:37]
    v_mul_u32_u24_sdwa v30, v15, v2 dst_sel:DWORD dst_unused:UNUSED_PAD src0_sel:WORD_1 src1_sel:DWORD
    v_mul_u32_u24_sdwa v31, v15, v3 dst_sel:DWORD dst_unused:UNUSED_PAD src0_sel:WORD_1 src1_sel:DWORD
    v_mul_u32_u24_sdwa v32, v15, v4 dst_sel:DWORD dst_unused:UNUSED_PAD src0_sel:WORD_1 src1_sel:DWORD
    v_mul_u32_u24_sdwa v33, v15, v5 dst_sel:DWORD dst_unused:UNUSED_PAD src0_sel:WORD_1 src1_sel:DWORD
    s_waitcnt vmcnt(21)
    v_mfma_f32_16x16x32_bf16 v[34:37], v[80:83], v[26:29], v[34:37]
    v_mul_u32_u24_sdwa v26, v16, v2 dst_sel:DWORD dst_unused:UNUSED_PAD src0_sel:WORD_0 src1_sel:DWORD
    v_mul_u32_u24_sdwa v27, v16, v3 dst_sel:DWORD dst_unused:UNUSED_PAD src0_sel:WORD_0 src1_sel:DWORD
    v_mul_u32_u24_sdwa v28, v16, v4 dst_sel:DWORD dst_unused:UNUSED_PAD src0_sel:WORD_0 src1_sel:DWORD
    v_mul_u32_u24_sdwa v29, v16, v5 dst_sel:DWORD dst_unused:UNUSED_PAD src0_sel:WORD_0 src1_sel:DWORD
    s_waitcnt vmcnt(20)
    v_mfma_f32_16x16x32_bf16 v[34:37], v[84:87], v[30:33], v[34:37]
    v_mul_u32_u24_sdwa v30, v16, v2 dst_sel:DWORD dst_unused:UNUSED_PAD src0_sel:WORD_1 src1_sel:DWORD
    v_mul_u32_u24_sdwa v31, v16, v3 dst_sel:DWORD dst_unused:UNUSED_PAD src0_sel:WORD_1 src1_sel:DWORD
    v_mul_u32_u24_sdwa v32, v16, v4 dst_sel:DWORD dst_unused:UNUSED_PAD src0_sel:WORD_1 src1_sel:DWORD
    v_mul_u32_u24_sdwa v33, v16, v5 dst_sel:DWORD dst_unused:UNUSED_PAD src0_sel:WORD_1 src1_sel:DWORD
    s_waitcnt vmcnt(19)
    v_mfma_f32_16x16x32_bf16 v[34:37], v[88:91], v[26:29], v[34:37]
    v_mul_u32_u24_sdwa v26, v17, v2 dst_sel:DWORD dst_unused:UNUSED_PAD src0_sel:WORD_0 src1_sel:DWORD
    v_mul_u32_u24_sdwa v27, v17, v3 dst_sel:DWORD dst_unused:UNUSED_PAD src0_sel:WORD_0 src1_sel:DWORD
    v_mul_u32_u24_sdwa v28, v17, v4 dst_sel:DWORD dst_unused:UNUSED_PAD src0_sel:WORD_0 src1_sel:DWORD
    v_mul_u32_u24_sdwa v29, v17, v5 dst_sel:DWORD dst_unused:UNUSED_PAD src0_sel:WORD_0 src1_sel:DWORD
    s_waitcnt vmcnt(18)
    v_mfma_f32_16x16x32_bf16 v[34:37], v[92:95], v[30:33], v[34:37]
    v_mul_u32_u24_sdwa v30, v17, v2 dst_sel:DWORD dst_unused:UNUSED_PAD src0_sel:WORD_1 src1_sel:DWORD
    v_mul_u32_u24_sdwa v31, v17, v3 dst_sel:DWORD dst_unused:UNUSED_PAD src0_sel:WORD_1 src1_sel:DWORD
    v_mul_u32_u24_sdwa v32, v17, v4 dst_sel:DWORD dst_unused:UNUSED_PAD src0_sel:WORD_1 src1_sel:DWORD
    v_mul_u32_u24_sdwa v33, v17, v5 dst_sel:DWORD dst_unused:UNUSED_PAD src0_sel:WORD_1 src1_sel:DWORD
    s_waitcnt vmcnt(17)
    v_mfma_f32_16x16x32_bf16 v[34:37], v[96:99], v[26:29], v[34:37]
    v_mul_u32_u24_sdwa v26, v18, v2 dst_sel:DWORD dst_unused:UNUSED_PAD src0_sel:WORD_0 src1_sel:DWORD
    v_mul_u32_u24_sdwa v27, v18, v3 dst_sel:DWORD dst_unused:UNUSED_PAD src0_sel:WORD_0 src1_sel:DWORD
    v_mul_u32_u24_sdwa v28, v18, v4 dst_sel:DWORD dst_unused:UNUSED_PAD src0_sel:WORD_0 src1_sel:DWORD
    v_mul_u32_u24_sdwa v29, v18, v5 dst_sel:DWORD dst_unused:UNUSED_PAD src0_sel:WORD_0 src1_sel:DWORD
    s_waitcnt vmcnt(16)
    v_mfma_f32_16x16x32_bf16 v[34:37], v[100:103], v[30:33], v[34:37]
    v_mul_u32_u24_sdwa v30, v18, v2 dst_sel:DWORD dst_unused:UNUSED_PAD src0_sel:WORD_1 src1_sel:DWORD
    v_mul_u32_u24_sdwa v31, v18, v3 dst_sel:DWORD dst_unused:UNUSED_PAD src0_sel:WORD_1 src1_sel:DWORD
    v_mul_u32_u24_sdwa v32, v18, v4 dst_sel:DWORD dst_unused:UNUSED_PAD src0_sel:WORD_1 src1_sel:DWORD
    v_mul_u32_u24_sdwa v33, v18, v5 dst_sel:DWORD dst_unused:UNUSED_PAD src0_sel:WORD_1 src1_sel:DWORD
    s_waitcnt vmcnt(15)
    v_mfma_f32_16x16x32_bf16 v[34:37], v[104:107], v[26:29], v[34:37]
    v_mul_u32_u24_sdwa v26, v19, v2 dst_sel:DWORD dst_unused:UNUSED_PAD src0_sel:WORD_0 src1_sel:DWORD
    v_mul_u32_u24_sdwa v27, v19, v3 dst_sel:DWORD dst_unused:UNUSED_PAD src0_sel:WORD_0 src1_sel:DWORD
    v_mul_u32_u24_sdwa v28, v19, v4 dst_sel:DWORD dst_unused:UNUSED_PAD src0_sel:WORD_0 src1_sel:DWORD
    v_mul_u32_u24_sdwa v29, v19, v5 dst_sel:DWORD dst_unused:UNUSED_PAD src0_sel:WORD_0 src1_sel:DWORD
    s_waitcnt vmcnt(14)
    v_mfma_f32_16x16x32_bf16 v[34:37], v[108:111], v[30:33], v[34:37]
    v_mul_u32_u24_sdwa v30, v19, v2 dst_sel:DWORD dst_unused:UNUSED_PAD src0_sel:WORD_1 src1_sel:DWORD
    v_mul_u32_u24_sdwa v31, v19, v3 dst_sel:DWORD dst_unused:UNUSED_PAD src0_sel:WORD_1 src1_sel:DWORD
    v_mul_u32_u24_sdwa v32, v19, v4 dst_sel:DWORD dst_unused:UNUSED_PAD src0_sel:WORD_1 src1_sel:DWORD
    v_mul_u32_u24_sdwa v33, v19, v5 dst_sel:DWORD dst_unused:UNUSED_PAD src0_sel:WORD_1 src1_sel:DWORD
    s_waitcnt vmcnt(13)
    v_mfma_f32_16x16x32_bf16 v[34:37], v[112:115], v[26:29], v[34:37]
    v_mul_u32_u24_sdwa v26, v20, v2 dst_sel:DWORD dst_unused:UNUSED_PAD src0_sel:WORD_0 src1_sel:DWORD
    v_mul_u32_u24_sdwa v27, v20, v3 dst_sel:DWORD dst_unused:UNUSED_PAD src0_sel:WORD_0 src1_sel:DWORD
    v_mul_u32_u24_sdwa v28, v20, v4 dst_sel:DWORD dst_unused:UNUSED_PAD src0_sel:WORD_0 src1_sel:DWORD
    v_mul_u32_u24_sdwa v29, v20, v5 dst_sel:DWORD dst_unused:UNUSED_PAD src0_sel:WORD_0 src1_sel:DWORD
    s_waitcnt vmcnt(12)
    v_mfma_f32_16x16x32_bf16 v[34:37], v[116:119], v[30:33], v[34:37]
    v_mul_u32_u24_sdwa v30, v20, v2 dst_sel:DWORD dst_unused:UNUSED_PAD src0_sel:WORD_1 src1_sel:DWORD
    v_mul_u32_u24_sdwa v31, v20, v3 dst_sel:DWORD dst_unused:UNUSED_PAD src0_sel:WORD_1 src1_sel:DWORD
    v_mul_u32_u24_sdwa v32, v20, v4 dst_sel:DWORD dst_unused:UNUSED_PAD src0_sel:WORD_1 src1_sel:DWORD
    v_mul_u32_u24_sdwa v33, v20, v5 dst_sel:DWORD dst_unused:UNUSED_PAD src0_sel:WORD_1 src1_sel:DWORD
    s_waitcnt vmcnt(11)
    v_mfma_f32_16x16x32_bf16 v[34:37], v[120:123], v[26:29], v[34:37]
    v_mul_u32_u24_sdwa v26, v21, v2 dst_sel:DWORD dst_unused:UNUSED_PAD src0_sel:WORD_0 src1_sel:DWORD
    v_mul_u32_u24_sdwa v27, v21, v3 dst_sel:DWORD dst_unused:UNUSED_PAD src0_sel:WORD_0 src1_sel:DWORD
    v_mul_u32_u24_sdwa v28, v21, v4 dst_sel:DWORD dst_unused:UNUSED_PAD src0_sel:WORD_0 src1_sel:DWORD
    v_mul_u32_u24_sdwa v29, v21, v5 dst_sel:DWORD dst_unused:UNUSED_PAD src0_sel:WORD_0 src1_sel:DWORD
    s_waitcnt vmcnt(10)
    v_mfma_f32_16x16x32_bf16 v[34:37], v[124:127], v[30:33], v[34:37]
    v_mul_u32_u24_sdwa v30, v21, v2 dst_sel:DWORD dst_unused:UNUSED_PAD src0_sel:WORD_1 src1_sel:DWORD
    v_mul_u32_u24_sdwa v31, v21, v3 dst_sel:DWORD dst_unused:UNUSED_PAD src0_sel:WORD_1 src1_sel:DWORD
    v_mul_u32_u24_sdwa v32, v21, v4 dst_sel:DWORD dst_unused:UNUSED_PAD src0_sel:WORD_1 src1_sel:DWORD
    v_mul_u32_u24_sdwa v33, v21, v5 dst_sel:DWORD dst_unused:UNUSED_PAD src0_sel:WORD_1 src1_sel:DWORD
    s_waitcnt vmcnt(9)
    v_mfma_f32_16x16x32_bf16 v[34:37], v[128:131], v[26:29], v[34:37]
    v_mul_u32_u24_sdwa v26, v22, v2 dst_sel:DWORD dst_unused:UNUSED_PAD src0_sel:WORD_0 src1_sel:DWORD
    v_mul_u32_u24_sdwa v27, v22, v3 dst_sel:DWORD dst_unused:UNUSED_PAD src0_sel:WORD_0 src1_sel:DWORD
    v_mul_u32_u24_sdwa v28, v22, v4 dst_sel:DWORD dst_unused:UNUSED_PAD src0_sel:WORD_0 src1_sel:DWORD
    v_mul_u32_u24_sdwa v29, v22, v5 dst_sel:DWORD dst_unused:UNUSED_PAD src0_sel:WORD_0 src1_sel:DWORD
    s_waitcnt vmcnt(8)
    v_mfma_f32_16x16x32_bf16 v[34:37], v[132:135], v[30:33], v[34:37]
    v_mul_u32_u24_sdwa v30, v22, v2 dst_sel:DWORD dst_unused:UNUSED_PAD src0_sel:WORD_1 src1_sel:DWORD
    v_mul_u32_u24_sdwa v31, v22, v3 dst_sel:DWORD dst_unused:UNUSED_PAD src0_sel:WORD_1 src1_sel:DWORD
    v_mul_u32_u24_sdwa v32, v22, v4 dst_sel:DWORD dst_unused:UNUSED_PAD src0_sel:WORD_1 src1_sel:DWORD
    v_mul_u32_u24_sdwa v33, v22, v5 dst_sel:DWORD dst_unused:UNUSED_PAD src0_sel:WORD_1 src1_sel:DWORD
    s_waitcnt vmcnt(7)
    v_mfma_f32_16x16x32_bf16 v[34:37], v[136:139], v[26:29], v[34:37]
    v_mul_u32_u24_sdwa v26, v23, v2 dst_sel:DWORD dst_unused:UNUSED_PAD src0_sel:WORD_0 src1_sel:DWORD
    v_mul_u32_u24_sdwa v27, v23, v3 dst_sel:DWORD dst_unused:UNUSED_PAD src0_sel:WORD_0 src1_sel:DWORD
    v_mul_u32_u24_sdwa v28, v23, v4 dst_sel:DWORD dst_unused:UNUSED_PAD src0_sel:WORD_0 src1_sel:DWORD
    v_mul_u32_u24_sdwa v29, v23, v5 dst_sel:DWORD dst_unused:UNUSED_PAD src0_sel:WORD_0 src1_sel:DWORD
    s_waitcnt vmcnt(6)
    v_mfma_f32_16x16x32_bf16 v[34:37], v[140:143], v[30:33], v[34:37]
    v_mul_u32_u24_sdwa v30, v23, v2 dst_sel:DWORD dst_unused:UNUSED_PAD src0_sel:WORD_1 src1_sel:DWORD
    v_mul_u32_u24_sdwa v31, v23, v3 dst_sel:DWORD dst_unused:UNUSED_PAD src0_sel:WORD_1 src1_sel:DWORD
    v_mul_u32_u24_sdwa v32, v23, v4 dst_sel:DWORD dst_unused:UNUSED_PAD src0_sel:WORD_1 src1_sel:DWORD
    v_mul_u32_u24_sdwa v33, v23, v5 dst_sel:DWORD dst_unused:UNUSED_PAD src0_sel:WORD_1 src1_sel:DWORD
    s_waitcnt vmcnt(5)
    v_mfma_f32_16x16x32_bf16 v[34:37], v[144:147], v[26:29], v[34:37]
    v_mul_u32_u24_sdwa v26, v24, v2 dst_sel:DWORD dst_unused:UNUSED_PAD src0_sel:WORD_0 src1_sel:DWORD
    v_mul_u32_u24_sdwa v27, v24, v3 dst_sel:DWORD dst_unused:UNUSED_PAD src0_sel:WORD_0 src1_sel:DWORD
    v_mul_u32_u24_sdwa v28, v24, v4 dst_sel:DWORD dst_unused:UNUSED_PAD src0_sel:WORD_0 src1_sel:DWORD
    v_mul_u32_u24_sdwa v29, v24, v5 dst_sel:DWORD dst_unused:UNUSED_PAD src0_sel:WORD_0 src1_sel:DWORD
    s_waitcnt vmcnt(4)
    v_mfma_f32_16x16x32_bf16 v[34:37], v[148:151], v[30:33], v[34:37]
    v_mul_u32_u24_sdwa v30, v24, v2 dst_sel:DWORD dst_unused:UNUSED_PAD src0_sel:WORD_1 src1_sel:DWORD
    v_mul_u32_u24_sdwa v31, v24, v3 dst_sel:DWORD dst_unused:UNUSED_PAD src0_sel:WORD_1 src1_sel:DWORD
    v_mul_u32_u24_sdwa v32, v24, v4 dst_sel:DWORD dst_unused:UNUSED_PAD src0_sel:WORD_1 src1_sel:DWORD
    v_mul_u32_u24_sdwa v33, v24, v5 dst_sel:DWORD dst_unused:UNUSED_PAD src0_sel:WORD_1 src1_sel:DWORD
    s_waitcnt vmcnt(3)
    v_mfma_f32_16x16x32_bf16 v[34:37], v[152:155], v[26:29], v[34:37]
    v_mul_u32_u24_sdwa v26, v25, v2 dst_sel:DWORD dst_unused:UNUSED_PAD src0_sel:WORD_0 src1_sel:DWORD
    v_mul_u32_u24_sdwa v27, v25, v3 dst_sel:DWORD dst_unused:UNUSED_PAD src0_sel:WORD_0 src1_sel:DWORD
    v_mul_u32_u24_sdwa v28, v25, v4 dst_sel:DWORD dst_unused:UNUSED_PAD src0_sel:WORD_0 src1_sel:DWORD
    v_mul_u32_u24_sdwa v29, v25, v5 dst_sel:DWORD dst_unused:UNUSED_PAD src0_sel:WORD_0 src1_sel:DWORD
    s_waitcnt vmcnt(2)
    v_mfma_f32_16x16x32_bf16 v[34:37], v[156:159], v[30:33], v[34:37]
    v_mul_u32_u24_sdwa v30, v25, v2 dst_sel:DWORD dst_unused:UNUSED_PAD src0_sel:WORD_1 src1_sel:DWORD
    v_mul_u32_u24_sdwa v31, v25, v3 dst_sel:DWORD dst_unused:UNUSED_PAD src0_sel:WORD_1 src1_sel:DWORD
    v_mul_u32_u24_sdwa v32, v25, v4 dst_sel:DWORD dst_unused:UNUSED_PAD src0_sel:WORD_1 src1_sel:DWORD
    v_mul_u32_u24_sdwa v33, v25, v5 dst_sel:DWORD dst_unused:UNUSED_PAD src0_sel:WORD_1 src1_sel:DWORD
    s_waitcnt vmcnt(1)
    v_mfma_f32_16x16x32_bf16 v[34:37], v[160:163], v[26:29], v[34:37]
    s_waitcnt vmcnt(0)
    v_mfma_f32_16x16x32_bf16 v[34:37], v[164:167], v[30:33], v[34:37]
    s_mov_b32 exec_lo, 0x00ff00ff
    s_mov_b32 exec_hi, 0x00ff00ff
    s_nop 5
    ds_write_b128 v38, v[34:37] offset:1536
    s_mov_b64 exec, 1
    ds_add_rtn_u32 v7, v6, v8 offset:24
    s_mov_b64 exec, -1
    ds_read2st64_b64 v[12:15], v9 offset0:3 offset1:4
    ds_read2st64_b64 v[16:19], v9 offset0:5 offset1:6
    ds_read_b64 v[20:21], v9 offset:3584
    s_waitcnt lgkmcnt(2)
    v_readfirstlane_b32 s98, v7
    v_pk_add_f32 v[12:13], v[12:13], v[14:15]
    s_waitcnt lgkmcnt(0)
    v_pk_add_f32 v[16:17], v[16:17], v[18:19]
    v_pk_add_f32 v[12:13], v[12:13], v[20:21]
    s_cmp_lg_u32 s98, 4
    v_pk_add_f32 v[12:13], v[12:13], v[16:17]
    s_cbranch_scc1 L_fin
    v_cvt_pk_bf16_f32 v12, v12, v13
    buffer_store_dword v12, v39, s[32:35], s64 offen sc1
L_fin:
    s_endpgm
L_tail:
    s_mul_i32 s64, s3, 12288
    s_add_u32 s64, s64, 16384
    v_lshrrev_b32 v14, 3, v0
    v_lshrrev_b32 v15, 4, v0
    v_xor_b32 v15, v15, v14
    v_and_b32 v15, 1, v15
    v_lshlrev_b32 v15, 6, v15
    v_and_b32 v16, 7, v0
    v_lshlrev_b32 v16, 4, v16
    v_xor_b32 v16, v16, v15
    s_cmp_ge_u32 s53, 27
    s_cbranch_scc1 L_cl
    s_cmp_ge_u32 s3, 10
    s_cbranch_scc1 L_ce
    v_mul_u32_u24 v9, 3456, v14
    v_add_u32 v9, v9, v16
    v_xor_b32 v10, 32, v9
    v_add_u32 v10, 26624, v10
    s_mul_i32 s69, s3, 221184
    s_lshl_b32 s70, s53, 7
    s_add_u32 s69, s69, s70
    s_mov_b32 s70, s69
    s_cmp_ge_u32 s3, 8
    s_waitcnt lgkmcnt(0)
    s_load_dword s52, s[30:31], 0
    s_mov_b32 s40, s16
    s_mov_b32 s41, s17
    s_mov_b32 s42, 2211840
    s_mov_b32 s43, 0x20000
    s_mov_b32 s44, s18
    s_mov_b32 s45, s19
    s_mov_b32 s46, 2211840
    s_mov_b32 s47, 0x20000
    s_cbranch_scc1 L_cd
    s_add_u32 m0, s64, 4096
    s_nop 0
    buffer_load_dwordx4 v9, s[40:43], s69 offen nt lds
    buffer_load_dwordx4 v10, s[40:43], s69 offen offset:1024 nt lds
    s_add_u32 m0, s64, 6144
    s_add_u32 s69, s69, 55296
    buffer_load_dwordx4 v9, s[40:43], s69 offen nt lds
    buffer_load_dwordx4 v10, s[40:43], s69 offen offset:1024 nt lds
    s_barrier
    s_add_u32 m0, s64, 8192
    s_add_u32 s69, s69, 55296
    buffer_load_dwordx4 v9, s[40:43], s69 offen nt lds
    buffer_load_dwordx4 v10, s[40:43], s69 offen offset:1024 nt lds
    s_add_u32 m0, s64, 10240
    s_add_u32 s69, s69, 55296
    buffer_load_dwordx4 v9, s[40:43], s69 offen nt lds
    buffer_load_dwordx4 v10, s[40:43], s69 offen offset:1024 nt lds
    s_add_u32 m0, s64, 0
    s_nop 0
    buffer_load_dwordx4 v9, s[44:47], s70 offen nt lds
    buffer_load_dwordx4 v10, s[44:47], s70 offen offset:1024 nt lds
    v_mul_u32_u24 v11, 1280, v14
    v_add_u32 v11, v11, v16
    v_xor_b32 v12, 32, v11
    v_add_u32 v12, 9216, v12
    v_bfe_u32 v16, v0, 2, 1
    v_mul_u32_u24 v16, 1056, v16
    v_lshl_add_u32 v16, v14, 7, v16
    v_and_b32 v17, 3, v0
    v_lshl_add_u32 v16, v17, 3, v16
    v_add3_u32 v2, v16, v15, s64
    v_xor_b32 v3, 32, v2
    v_xor_b32 v4, 64, v2
    v_xor_b32 v5, 96, v2
    v_and_b32 v13, 1, v0
    v_cmp_eq_u32 vcc, 1, v13
    v_mov_b32 v13, 0x44444444
    v_mov_b32 v17, 0x4444eeee
    v_cndmask_b32 v13, v13, v17, vcc
    v_bfe_u32 v17, v0, 3, 1
    v_mul_u32_u24 v17, 0xaaaa, v17
    v_lshl_add_u32 v13, v17, 16, v13
    s_mov_b32 s32, s30
    s_mov_b32 s33, s31
    s_mov_b32 s34, 660736
    s_mov_b32 s35, 0x20000
    s_waitcnt lgkmcnt(0)
    s_mul_i32 s52, s52, 0x5bd1e9c5
    s_add_u32 s52, s52, 0x6a09e6b7
    s_mul_i32 s65, s53, 205
    s_lshr_b32 s65, s65, 10
    s_mul_i32 s66, s65, 5
    s_sub_u32 s66, s53, s66
    s_lshr_b32 s63, s66, 1
    s_and_b32 s67, s66, 1
    s_lshl3_add_u32 s74, s67, s3
    s_add_u32 s74, s74, 7
    s_movk_i32 s50, 7
    s_bfe_u32 s68, s3, 0x10002
    s_and_b32 s72, s3, 3
    s_add_u32 s72, s72, 23
    s_cmp_eq_u32 s66, 4
    s_cmov_b32 s63, s68
    s_cmov_b32 s74, s72
    s_cmovk_i32 s67, 2
    s_cmovk_i32 s50, 3
    s_lshl1_add_u32 s63, s65, s63
    s_cmp_ge_u32 s53, 25
    s_cmovk_i32 s63, 0
    s_cmovk_i32 s65, 0
    s_cselect_b32 s66, 0, 1
    s_lshl_b32 s75, s63, 10
    s_add_u32 s75, s75, 302336
    s_mov_b32 s56, s12
    s_mov_b32 s57, s13
    s_mov_b32 s58, 5242880
    s_mov_b32 s59, 0x20000
    s_mul_i32 s71, s74, 163840
    s_lshl_b32 s72, s63, 7
    s_add_u32 s71, s71, s72
    s_add_u32 s62, s71, 81920
    s_cmp_eq_u32 s66, 0
    s_cmov_b32 s58, 0
    s_waitcnt vmcnt(8) lgkmcnt(0)
    ds_read_b64_tr_b16 v[40:41], v2 offset:4096
    ds_read_b64_tr_b16 v[48:49], v3 offset:4096
    ds_read_b64_tr_b16 v[56:57], v4 offset:4096
    ds_read_b64_tr_b16 v[64:65], v5 offset:4096
    s_add_u32 m0, s64, 2048
    s_add_u32 s70, s70, 55296
    buffer_load_dwordx4 v9, s[44:47], s70 offen nt lds
    buffer_load_dwordx4 v10, s[44:47], s70 offen offset:1024 nt lds
    s_waitcnt vmcnt(8) lgkmcnt(0)
    ds_read_b64_tr_b16 v[42:43], v2 offset:6144
    ds_read_b64_tr_b16 v[50:51], v3 offset:6144
    ds_read_b64_tr_b16 v[58:59], v4 offset:6144
    ds_read_b64_tr_b16 v[66:67], v5 offset:6144
    s_add_u32 m0, s64, 4096
    s_add_u32 s70, s70, 55296
    buffer_load_dwordx4 v9, s[44:47], s70 offen nt lds
    buffer_load_dwordx4 v10, s[44:47], s70 offen offset:1024 nt lds
    s_waitcnt vmcnt(8) lgkmcnt(0)
    ds_read_b64_tr_b16 v[44:45], v2 offset:8192
    ds_read_b64_tr_b16 v[52:53], v3 offset:8192
    ds_read_b64_tr_b16 v[60:61], v4 offset:8192
    ds_read_b64_tr_b16 v[68:69], v5 offset:8192
    s_add_u32 m0, s64, 6144
    s_add_u32 s70, s70, 55296
    buffer_load_dwordx4 v9, s[44:47], s70 offen nt lds
    buffer_load_dwordx4 v10, s[44:47], s70 offen offset:1024 nt lds
    s_waitcnt vmcnt(8) lgkmcnt(0)
    ds_read_b64_tr_b16 v[46:47], v2 offset:10240
    ds_read_b64_tr_b16 v[54:55], v3 offset:10240
    ds_read_b64_tr_b16 v[62:63], v4 offset:10240
    ds_read_b64_tr_b16 v[70:71], v5 offset:10240
    s_add_u32 m0, s64, 8192
    s_nop 0
    buffer_load_dwordx4 v11, s[56:59], s71 offen nt lds
    buffer_load_dwordx4 v12, s[56:59], s71 offen offset:1024 nt lds
    s_waitcnt vmcnt(8) lgkmcnt(0)
    ds_read_b64_tr_b16 v[72:73], v2 offset:0
    ds_read_b64_tr_b16 v[80:81], v3 offset:0
    ds_read_b64_tr_b16 v[88:89], v4 offset:0
    ds_read_b64_tr_b16 v[96:97], v5 offset:0
    s_add_u32 m0, s64, 10240
    s_add_u32 s71, s71, 20480
    buffer_load_dwordx4 v11, s[56:59], s71 offen nt lds
    buffer_load_dwordx4 v12, s[56:59], s71 offen offset:1024 nt lds
    s_waitcnt vmcnt(8) lgkmcnt(0)
    ds_read_b64_tr_b16 v[74:75], v2 offset:2048
    ds_read_b64_tr_b16 v[82:83], v3 offset:2048
    ds_read_b64_tr_b16 v[90:91], v4 offset:2048
    ds_read_b64_tr_b16 v[98:99], v5 offset:2048
    s_add_u32 m0, s64, 0
    s_add_u32 s71, s71, 20480
    buffer_load_dwordx4 v11, s[56:59], s71 offen nt lds
    buffer_load_dwordx4 v12, s[56:59], s71 offen offset:1024 nt lds
    s_waitcnt vmcnt(8) lgkmcnt(0)
    ds_read_b64_tr_b16 v[76:77], v2 offset:4096
    ds_read_b64_tr_b16 v[84:85], v3 offset:4096
    ds_read_b64_tr_b16 v[92:93], v4 offset:4096
    ds_read_b64_tr_b16 v[100:101], v5 offset:4096
    s_add_u32 m0, s64, 2048
    s_add_u32 s71, s71, 20480
    buffer_load_dwordx4 v11, s[56:59], s71 offen nt lds
    buffer_load_dwordx4 v12, s[56:59], s71 offen offset:1024 nt lds
    s_waitcnt vmcnt(8) lgkmcnt(0)
    ds_read_b64_tr_b16 v[78:79], v2 offset:6144
    ds_read_b64_tr_b16 v[86:87], v3 offset:6144
    ds_read_b64_tr_b16 v[94:95], v4 offset:6144
    ds_read_b64_tr_b16 v[102:103], v5 offset:6144
    s_add_u32 m0, s64, 4096
    s_nop 0
    buffer_load_dwordx4 v11, s[56:59], s62 offen nt lds
    buffer_load_dwordx4 v12, s[56:59], s62 offen offset:1024 nt lds
    s_waitcnt vmcnt(8) lgkmcnt(0)
    ds_read_b64_tr_b16 v[104:105], v2 offset:8192
    ds_read_b64_tr_b16 v[112:113], v3 offset:8192
    ds_read_b64_tr_b16 v[120:121], v4 offset:8192
    ds_read_b64_tr_b16 v[128:129], v5 offset:8192
    s_add_u32 m0, s64, 6144
    s_add_u32 s62, s62, 20480
    buffer_load_dwordx4 v11, s[56:59], s62 offen nt lds
    buffer_load_dwordx4 v12, s[56:59], s62 offen offset:1024 nt lds
    s_waitcnt vmcnt(8) lgkmcnt(0)
    ds_read_b64_tr_b16 v[106:107], v2 offset:10240
    ds_read_b64_tr_b16 v[114:115], v3 offset:10240
    ds_read_b64_tr_b16 v[122:123], v4 offset:10240
    ds_read_b64_tr_b16 v[130:131], v5 offset:10240
    s_add_u32 m0, s64, 8192
    s_add_u32 s62, s62, 20480
    buffer_load_dwordx4 v11, s[56:59], s62 offen nt lds
    buffer_load_dwordx4 v12, s[56:59], s62 offen offset:1024 nt lds
    s_waitcnt vmcnt(8) lgkmcnt(0)
    ds_read_b64_tr_b16 v[108:109], v2 offset:0
    ds_read_b64_tr_b16 v[116:117], v3 offset:0
    ds_read_b64_tr_b16 v[124:125], v4 offset:0
    ds_read_b64_tr_b16 v[132:133], v5 offset:0
    s_add_u32 m0, s64, 10240
    s_add_u32 s62, s62, 20480
    buffer_load_dwordx4 v11, s[56:59], s62 offen nt lds
    buffer_load_dwordx4 v12, s[56:59], s62 offen offset:1024 nt lds
    s_mov_b64 exec, 1
    v_mov_b32 v8, 1
    ds_add_u32 v6, v8 offset:0
    s_mov_b64 exec, -1
    v_lshlrev_b32 v12, 4, v0
    v_bfe_u32 v7, v0, 1, 3
    v_lshlrev_b32 v9, 8, v7
    v_bfe_u32 v7, v0, 0, 1
    v_lshl_add_u32 v9, v7, 6, v9
    v_bfe_u32 v7, v0, 4, 2
    v_lshl_add_u32 v9, v7, 4, v9
    v_bfe_u32 v7, v0, 0, 2
    v_lshlrev_b32 v14, 6, v7
    v_bfe_u32 v7, v0, 4, 2
    v_lshl_add_u32 v14, v7, 4, v14
    s_lshl_b32 s84, s3, 8
    v_add_u32 v14, s84, v14
    v_lshl_add_u32 v15, v0, 4, s64
W_29:
    ds_read_b32 v7, v6 offset:4
    s_waitcnt lgkmcnt(0)
    v_readfirstlane_b32 s98, v7
    s_cmp_ge_u32 s98, 1
    s_nop 2
    s_cbranch_scc1 WD_30
    s_sleep 1
    s_sub_u32 s99, s99, 1
    s_cbranch_scc0 W_29
    s_mov_b32 s99, 0
WD_30:
    s_lshr_b32 s73, s98, 1
    s_cselect_b64 s[76:77], -1, 0
    s_not_b64 s[78:79], s[76:77]
    ds_read_b128 v[16:19], v14 offset:8704
    v_mov_b64 v[24:25], 0
    v_mov_b64 v[26:27], 0
    v_mov_b64 v[28:29], 0
    v_mov_b64 v[30:31], 0
    v_mov_b64 v[32:33], 0
    v_mov_b64 v[34:35], 0
    v_mov_b64 v[36:37], 0
    v_mov_b64 v[38:39], 0
    s_waitcnt lgkmcnt(0)
    v_smfmac_f32_16x16x64_bf16 v[24:27], v[16:19], v[40:47], v13
    v_smfmac_f32_16x16x64_bf16 v[28:31], v[16:19], v[48:55], v13
    v_smfmac_f32_16x16x64_bf16 v[32:35], v[16:19], v[56:63], v13
    v_smfmac_f32_16x16x64_bf16 v[36:39], v[16:19], v[64:71], v13
    s_nop 4
    v_add_f32_dpp v20, v24, v25 quad_perm:[0,1,2,3] row_mask:1 bank_mask:0xf
    v_add_f32_dpp v22, v26, v27 quad_perm:[0,1,2,3] row_mask:1 bank_mask:0xf
    s_nop 0
    v_add_f32_dpp v20, v28, v29 quad_perm:[0,1,2,3] row_mask:2 bank_mask:0xf
    v_add_f32_dpp v22, v30, v31 quad_perm:[0,1,2,3] row_mask:2 bank_mask:0xf
    s_nop 0
    v_add_f32_dpp v20, v32, v33 quad_perm:[0,1,2,3] row_mask:4 bank_mask:0xf
    v_add_f32_dpp v22, v34, v35 quad_perm:[0,1,2,3] row_mask:4 bank_mask:0xf
    s_nop 0
    v_add_f32_dpp v20, v36, v37 quad_perm:[0,1,2,3] row_mask:8 bank_mask:0xf
    v_add_f32_dpp v22, v38, v39 quad_perm:[0,1,2,3] row_mask:8 bank_mask:0xf
    v_mov_b64 v[24:25], 0
    v_mov_b64 v[26:27], 0
    v_mov_b64 v[28:29], 0
    v_mov_b64 v[30:31], 0
    v_mov_b64 v[32:33], 0
    v_mov_b64 v[34:35], 0
    v_mov_b64 v[36:37], 0
    v_mov_b64 v[38:39], 0
    s_waitcnt lgkmcnt(0)
    v_smfmac_f32_16x16x64_bf16 v[24:27], v[16:19], v[72:79], v13
    v_smfmac_f32_16x16x64_bf16 v[28:31], v[16:19], v[80:87], v13
    v_smfmac_f32_16x16x64_bf16 v[32:35], v[16:19], v[88:95], v13
    v_smfmac_f32_16x16x64_bf16 v[36:39], v[16:19], v[96:103], v13
    s_nop 4
    v_add_f32_dpp v21, v24, v25 quad_perm:[0,1,2,3] row_mask:1 bank_mask:0xf
    v_add_f32_dpp v23, v26, v27 quad_perm:[0,1,2,3] row_mask:1 bank_mask:0xf
    s_nop 0
    v_add_f32_dpp v21, v28, v29 quad_perm:[0,1,2,3] row_mask:2 bank_mask:0xf
    v_add_f32_dpp v23, v30, v31 quad_perm:[0,1,2,3] row_mask:2 bank_mask:0xf
    s_nop 0
    v_add_f32_dpp v21, v32, v33 quad_perm:[0,1,2,3] row_mask:4 bank_mask:0xf
    v_add_f32_dpp v23, v34, v35 quad_perm:[0,1,2,3] row_mask:4 bank_mask:0xf
    s_nop 0
    v_add_f32_dpp v21, v36, v37 quad_perm:[0,1,2,3] row_mask:8 bank_mask:0xf
    v_add_f32_dpp v23, v38, v39 quad_perm:[0,1,2,3] row_mask:8 bank_mask:0xf
    ds_write_b128 v15, v[20:23]
    s_mov_b64 exec, 1
    v_mov_b32 v8, 1
    ds_add_u32 v6, v8 offset:8
    s_mov_b64 exec, -1
    s_mul_i32 s84, s3, 27
    s_add_u32 s84, s84, s53
    s_lshr_b32 s85, s84, 3
    s_lshl_b32 s85, s85, 5
    s_and_b32 s86, s84, 7
    s_add_u32 s85, s85, s86
    s_lshl_b32 s85, s85, 1
    v_and_b32 v24, 49, v0
    v_add_u32 v24, s85, v24
    v_min_u32 v24, 639, v24
    v_lshlrev_b32 v15, 3, v24
    s_lshl_b32 s49, s74, 7
    s_add_u32 s49, s49, 217088
    s_lshl_b32 s74, s74, 11
    s_add_u32 s74, s74, 236800
    s_mov_b32 s85, 60416
    s_mov_b32 s86, 80896
    v_and_b32 v14, 7, v0
    v_min_u32 v14, 6, v14
    v_lshlrev_b32 v14, 4, v14
    v_and_b32 v7, 7, v0
    v_cmp_eq_u32 s[70:71], 7, v7
    s_mov_b32 s92, 0x3fff3fff
    s_mov_b32 s93, s92
    v_mov_b64 v[16:17], 0
    v_mov_b64 v[18:19], 0
    v_mov_b64 v[20:21], 0
    v_mov_b64 v[22:23], 0
    v_bfe_u32 v7, v0, 3, 2
    v_lshlrev_b32 v10, 3, v7
    v_bfe_u32 v7, v0, 1, 2
    v_lshl_add_u32 v10, v7, 5, v10
    v_bfe_u32 v7, v0, 0, 1
    v_lshl_add_u32 v10, v7, 7, v10
    v_bfe_u32 v7, v0, 5, 1
    v_lshl_add_u32 v10, v7, 8, v10
    s_and_b32 s87, s63, 1
    s_lshl_b32 s88, s87, 9
    s_lshl_b32 s87, s87, 10
    v_add_u32 v10, s88, v10
    v_and_b32 v11, 0x1f0, v12
    v_add_u32 v11, s88, v11
    v_add_u32 v27, s64, v12
    v_add_u32 v12, s87, v12
    v_bfe_u32 v7, v0, 0, 3
    v_lshlrev_b32 v8, 2, v7
    v_bfe_u32 v7, v0, 4, 1
    v_lshl_add_u32 v8, v7, 5, v8
    v_bfe_u32 v7, v0, 3, 1
    v_lshl_add_u32 v8, v7, 6, v8
    v_bfe_u32 v7, v0, 0, 2
    v_lshlrev_b32 v25, 2, v7
    v_bfe_u32 v7, v0, 2, 4
    v_lshl_add_u32 v25, v7, 6, v25
    s_lshl_b32 s60, s67, 7
    s_lshl_b32 s61, s67, 4
    v_add_u32 v8, s60, v8
    v_add_u32 v25, s61, v25
    v_cmp_gt_u32 vcc, 32, v0
    s_nop 1
    v_cndmask_b32 v8, v25, v8, vcc
    s_lshl_b32 s80, s3, 10
    s_add_u32 s80, s80, 302336
    s_lshl_b32 s83, s84, 4
    s_add_u32 s83, s83, 312576
    s_mov_b32 s87, 302848
    s_mov_b32 s90, -1
    s_mov_b32 s91, 0x003fffff
    s_mov_b32 s94, 0x33333333
    s_mov_b32 s95, s94
    v_bfe_u32 v7, v24, 6, 4
    v_lshlrev_b32 v25, 10, v7
    v_bfe_u32 v7, v24, 2, 1
    v_lshl_add_u32 v25, v7, 6, v25
    v_bfe_u32 v7, v24, 0, 1
    v_lshl_add_u32 v25, v7, 7, v25
    v_bfe_u32 v7, v24, 5, 1
    v_lshl_add_u32 v25, v7, 8, v25
    v_bfe_u32 v7, v24, 4, 1
    v_lshl_add_u32 v25, v7, 2, v25
    v_bfe_u32 v7, v24, 1, 1
    v_lshl_add_u32 v25, v7, 3, v25
    v_bfe_u32 v7, v0, 1, 2
    v_lshl_add_u32 v25, v7, 4, v25
    v_lshrrev_b32 v26, 1, v0
    v_mul_u32_u24 v26, 1408, v26
    v_and_b32 v7, 1, v0
    v_lshl_add_u32 v26, v7, 3, v26
    v_and_b32 v7, 8, v24
    v_cmp_eq_u32 s[88:89], 0, v7
    v_lshlrev_b32 v24, 1, v24
    s_mov_b32 s56, s26
    s_mov_b32 s57, s27
    s_mov_b32 s58, 1280
    s_mov_b32 s59, 0x20000
    s_waitcnt vmcnt(8)
    ds_read_b64_tr_b16 v[110:111], v2 offset:2048
    ds_read_b64_tr_b16 v[118:119], v3 offset:2048
    ds_read_b64_tr_b16 v[126:127], v4 offset:2048
    ds_read_b64_tr_b16 v[134:135], v5 offset:2048
    s_waitcnt vmcnt(6)
    ds_read_b64_tr_b16 v[136:137], v2 offset:4096
    ds_read_b64_tr_b16 v[144:145], v3 offset:4096
    ds_read_b64_tr_b16 v[152:153], v4 offset:4096
    ds_read_b64_tr_b16 v[160:161], v5 offset:4096
    s_waitcnt vmcnt(4)
    ds_read_b64_tr_b16 v[138:139], v2 offset:6144
    ds_read_b64_tr_b16 v[146:147], v3 offset:6144
    ds_read_b64_tr_b16 v[154:155], v4 offset:6144
    ds_read_b64_tr_b16 v[162:163], v5 offset:6144
    s_waitcnt vmcnt(2)
    ds_read_b64_tr_b16 v[140:141], v2 offset:8192
    ds_read_b64_tr_b16 v[148:149], v3 offset:8192
    ds_read_b64_tr_b16 v[156:157], v4 offset:8192
    ds_read_b64_tr_b16 v[164:165], v5 offset:8192
    s_waitcnt vmcnt(0)
    ds_read_b64_tr_b16 v[142:143], v2 offset:10240
    ds_read_b64_tr_b16 v[150:151], v3 offset:10240
    ds_read_b64_tr_b16 v[158:159], v4 offset:10240
    ds_read_b64_tr_b16 v[166:167], v5 offset:10240
W_31:
    ds_read_b32 v7, v6 offset:0
    s_waitcnt lgkmcnt(0)
    v_readfirstlane_b32 s98, v7
    s_cmp_ge_u32 s98, 10
    s_nop 2
    s_cbranch_scc1 WD_32
    s_sleep 1
    s_sub_u32 s99, s99, 1
    s_cbranch_scc0 W_31
    s_mov_b32 s99, 0
WD_32:
P_33:
    buffer_load_dwordx4 v[28:31], v14, s[32:35], s49 offen sc1
    buffer_load_dwordx2 v[32:33], v15, s[32:35], s85 offen sc1
    buffer_load_dwordx2 v[34:35], v15, s[32:35], s86 offen sc1
    s_waitcnt vmcnt(0)
    v_cmp_ne_u32 vcc, s52, v29
    v_cmp_ne_u32 s[96:97], s52, v31
    s_or_b64 vcc, vcc, s[96:97]
    v_cmp_ne_u32 s[96:97], s52, v33
    s_or_b64 vcc, vcc, s[96:97]
    v_cmp_ne_u32 s[96:97], s52, v35
    s_or_b64 vcc, vcc, s[96:97]
    s_cmp_eq_u64 vcc, 0
    s_nop 1
    s_cbranch_scc1 PD_34
    s_sleep 2
    s_sub_u32 s99, s99, 16
    s_cbranch_scc0 P_33
    s_mov_b32 s99, 0
PD_34:
    s_mov_b64 exec, s[92:93]
    buffer_load_dwordx4 v[16:19], v9, s[32:35], s74 offen sc1
    buffer_load_dwordx4 v[20:23], v9, s[32:35], s74 offen offset:128 sc1
    s_mov_b64 exec, -1
    s_cmp_lt_u32 s84, 80
    s_cselect_b32 s68, 0x00ff00ff, 0
    s_mov_b32 s69, s68
    s_mov_b32 s60, 0x0f0f0f0f
    s_mov_b32 s61, 0xf0f0f0f0
    v_mov_b32 v7, v27
    v_add_f32 v27, v32, v34
    v_cvt_pk_bf16_f32 v27, v27, v27
    v_and_b32 v27, 0xffff0000, v27
    ds_write_b128 v7, v[24:27] offset:1024
    v_mov_b32 v29, v28
    s_nop 1
    v_max_f32_dpp v29, v29, v29 row_half_mirror row_mask:0xf bank_mask:0xf
    s_nop 1
    v_max_f32_dpp v29, v29, v29 quad_perm:[1,0,3,2] row_mask:0xf bank_mask:0xf
    s_nop 1
    v_max_f32_dpp v29, v29, v29 quad_perm:[2,3,0,1] row_mask:0xf bank_mask:0xf
    v_sub_f32 v28, v28, v29
    v_mul_f32 v28, 0x3fb8aa3b, v28
    v_exp_f32 v28, v28
    s_nop 0
    v_cndmask_b32 v28, v28, 0, s[70:71]
    v_mul_f32 v29, v28, v30
    s_nop 1
    v_add_f32_dpp v29, v29, v29 row_half_mirror row_mask:0xf bank_mask:0xf
    s_nop 1
    v_add_f32_dpp v29, v29, v29 quad_perm:[1,0,3,2] row_mask:0xf bank_mask:0xf
    s_nop 1
    v_add_f32_dpp v29, v29, v29 quad_perm:[2,3,0,1] row_mask:0xf bank_mask:0xf
    v_rcp_f32 v29, v29
    s_nop 0
    v_mul_f32 v28, v28, v29
    v_cvt_pk_bf16_f32 v15, v28, v28
    v_mov_b32 v14, 0
    v_mov_b64 v[24:25], 0
    v_mov_b64 v[26:27], 0
    v_mov_b64 v[28:29], 0
    v_mov_b64 v[30:31], 0
    v_mov_b64 v[32:33], 0
    v_mov_b64 v[34:35], 0
    v_mov_b64 v[36:37], 0
    v_mov_b64 v[38:39], 0
    v_mov_b32_dpp v2, v15 row_newbcast:0 row_mask:5 bank_mask:0xf
    v_mov_b32_dpp v3, v15 row_newbcast:1 row_mask:5 bank_mask:0xf
    v_mov_b32_dpp v4, v15 row_newbcast:2 row_mask:5 bank_mask:0xf
    v_mov_b32_dpp v5, v15 row_newbcast:3 row_mask:5 bank_mask:0xf
    v_mov_b32_dpp v2, v15 row_newbcast:4 row_mask:10 bank_mask:0xf
    v_mov_b32_dpp v3, v15 row_newbcast:5 row_mask:10 bank_mask:0xf
    v_mov_b32_dpp v4, v15 row_newbcast:6 row_mask:10 bank_mask:0xf
    v_mov_b32_dpp v5, v15 row_newbcast:7 row_mask:10 bank_mask:0xf
    v_cndmask_b32 v2, 0, v2, s[60:61]
    v_cndmask_b32 v3, 0, v3, s[60:61]
    v_cndmask_b32 v4, 0, v4, s[60:61]
    v_cndmask_b32 v5, 0, v5, s[60:61]
    s_waitcnt lgkmcnt(0)
    v_lshl_add_u32 v15, v0, 4, s64
    s_cmp_eq_u32 s66, 0
    s_cbranch_scc1 L_t1d
    s_waitcnt vmcnt(0)
    v_max3_u32 v7, v16, v17, v18
    v_max3_u32 v7, v19, v20, v7
    v_max3_u32 v7, v21, v22, v7
    v_max_u32 v7, v23, v7
    v_cmp_eq_u32 vcc, -1, v7
    s_cbranch_vccz SD_36
W_37:
    ds_read_b32 v7, v6 offset:0
    s_waitcnt lgkmcnt(0)
    v_readfirstlane_b32 s98, v7
    s_cmp_ge_u32 s98, 12
    s_nop 2
    s_cbranch_scc1 WD_38
    s_sleep 1
    s_sub_u32 s99, s99, 1
    s_cbranch_scc0 W_37
    s_mov_b32 s99, 0
WD_38:
S_35:
    s_mov_b64 exec, vcc
    buffer_load_dwordx4 v[16:19], v9, s[32:35], s74 offen sc1
    buffer_load_dwordx4 v[20:23], v9, s[32:35], s74 offen offset:128 sc1
    s_sub_u32 s99, s99, 16
    s_cselect_b32 s99, 0, s99
    s_cselect_b64 exec, 0, -1
    s_waitcnt vmcnt(0)
    v_max3_u32 v7, v16, v17, v18
    v_max3_u32 v7, v19, v20, v7
    v_max3_u32 v7, v21, v22, v7
    v_max_u32 v7, v23, v7
    v_cmp_eq_u32 vcc, -1, v7
    s_mov_b64 exec, -1
    s_cbranch_vccnz S_35
SD_36:
    v_smfmac_f32_16x16x64_bf16 v[24:27], v[16:19], v[104:111], v13
    v_smfmac_f32_16x16x64_bf16 v[24:27], v[20:23], v[136:143], v13
    s_nop 2
    v_smfmac_f32_16x16x64_bf16 v[28:31], v[16:19], v[112:119], v13
    s_nop 1
    ds_read_b128 v[136:139], v12 offset:6656
    v_smfmac_f32_16x16x64_bf16 v[28:31], v[20:23], v[144:151], v13
    s_nop 1
    v_cvt_pk_bf16_f32 v104, v24, v25
    v_smfmac_f32_16x16x64_bf16 v[32:35], v[16:19], v[120:127], v13
    s_nop 1
    v_cvt_pk_bf16_f32 v106, v26, v27
    v_smfmac_f32_16x16x64_bf16 v[32:35], v[20:23], v[152:159], v13
    s_nop 1
    v_cvt_pk_bf16_f32 v108, v28, v29
    v_smfmac_f32_16x16x64_bf16 v[36:39], v[16:19], v[128:135], v13
    s_nop 1
    v_cvt_pk_bf16_f32 v110, v30, v31
    v_smfmac_f32_16x16x64_bf16 v[36:39], v[20:23], v[160:167], v13
    s_nop 1
    v_cvt_pk_bf16_f32 v105, v32, v33
    v_cvt_pk_bf16_f32 v107, v34, v35
    s_nop 3
    v_cvt_pk_bf16_f32 v109, v36, v37
    v_cvt_pk_bf16_f32 v111, v38, v39
    s_nop 1
    v_smfmac_f32_16x16x64_bf16 v[14:17], v[2:5], v[104:111], v13 abid:1
    s_nop 7
    v_cvt_f64_f32 v[18:19], v14
    ds_add_f64 v10, v[18:19] offset:256
    ds_inc_rtn_u32 v7, v10, v13 offset:1280
    ds_read_b128 v[20:23], v11 offset:256
    v_lshl_add_u32 v15, v0, 4, s64
    s_waitcnt lgkmcnt(1)
    v_cmp_eq_u32 vcc, s50, v7
    s_waitcnt lgkmcnt(0)
    v_cvt_f32_f64 v20, v[20:21]
    v_cvt_f32_f64 v21, v[22:23]
    s_and_b64 s[76:77], vcc, s[76:77]
    s_and_b64 s[78:79], vcc, s[78:79]
    v_fma_f32 v20, v20, v136, v138
    v_fma_f32 v21, v21, v137, v139
    v_cvt_pk_bf16_f32 v20, v20, v21
    s_mov_b64 exec, s[76:77]
    buffer_store_dword v20, v8, s[32:35], s75 offen offset:0
    s_mov_b64 exec, s[78:79]
    buffer_store_dword v20, v8, s[32:35], s75 offen offset:0 sc1
    s_mov_b64 exec, -1
L_t1d:
    ds_read_b128 v[2:5], v15 offset:1024
    v_cndmask_b32 v14, 0, -1, s[68:69]
    v_mov_b64 v[124:125], 0
    v_mov_b64 v[126:127], 0
    v_bfe_u32 v7, v0, 2, 2
    v_lshlrev_b32 v9, 7, v7
    v_bfe_u32 v7, v0, 0, 1
    v_lshl_add_u32 v9, v7, 6, v9
    v_bfe_u32 v7, v0, 4, 2
    v_lshl_add_u32 v9, v7, 4, v9
    v_mov_b64 v[24:25], 0
    v_mov_b64 v[28:29], 0
    v_mov_b64 v[32:33], 0
    v_mov_b64 v[36:37], 0
    v_mov_b64 v[104:105], 0
    v_mov_b64 v[108:109], 0
    v_mov_b64 v[112:113], 0
    v_mov_b64 v[116:117], 0
    v_mov_b64 v[140:141], 0
    v_mov_b32 v7, 0x3f803f80
    s_mov_b32 s60, 0x000f000f
    s_mov_b32 s61, 0x0f000f00
    s_lshl_b64 s[62:63], s[60:61], 4
    v_lshlrev_b32 v10, 3, v0
    v_cndmask_b32 v136, 0, v7, s[60:61]
    v_cndmask_b32 v137, 0, v7, s[62:63]
    v_cndmask_b32 v138, 0, v7, s[60:61]
    v_cndmask_b32 v139, 0, v7, s[62:63]
    s_waitcnt lgkmcnt(0)
    s_barrier
    s_mov_b64 vcc, s[94:95]
S_39:
    s_mov_b64 exec, vcc
    buffer_load_dwordx4 v[124:127], v9, s[32:35], s80 offen sc1
    s_sub_u32 s99, s99, 16
    s_cselect_b32 s99, 0, s99
    s_cselect_b64 exec, 0, -1
    s_waitcnt vmcnt(0)
    v_max3_u32 v7, v124, v125, v126
    v_max_u32 v7, v127, v7
    v_cmp_eq_u32 vcc, -1, v7
    s_mov_b64 exec, -1
    s_cbranch_vccnz S_39
    v_smfmac_f32_16x16x64_bf16 v[24:27], v[124:127], v[72:79], v13
    s_nop 2
    v_smfmac_f32_16x16x64_bf16 v[28:31], v[124:127], v[80:87], v13
    s_mov_b64 exec, s[68:69]
    buffer_load_dword v14, v3, s[32:35], s87 offen sc1
    s_mov_b64 exec, -1
    v_smfmac_f32_16x16x64_bf16 v[32:35], v[124:127], v[88:95], v13
    s_nop 1
    v_cvt_pk_bf16_f32 v129, v24, v25
    v_smfmac_f32_16x16x64_bf16 v[36:39], v[124:127], v[96:103], v13
    s_nop 1
    v_cvt_pk_bf16_f32 v131, v28, v29
    v_smfmac_f32_16x16x64_bf16 v[104:107], v[124:127], v[40:47], v13
    s_nop 1
    v_cvt_pk_bf16_f32 v133, v32, v33
    v_smfmac_f32_16x16x64_bf16 v[108:111], v[124:127], v[48:55], v13
    s_nop 1
    v_cvt_pk_bf16_f32 v135, v36, v37
    v_smfmac_f32_16x16x64_bf16 v[112:115], v[124:127], v[56:63], v13
    s_nop 1
    v_cvt_pk_bf16_f32 v128, v104, v105
    v_smfmac_f32_16x16x64_bf16 v[116:119], v[124:127], v[64:71], v13
    s_nop 1
    v_cvt_pk_bf16_f32 v130, v108, v109
    s_nop 0
    v_cvt_pk_bf16_f32 v132, v112, v113
    s_nop 2
    v_cvt_pk_bf16_f32 v134, v116, v117
    s_nop 1
    v_smfmac_f32_16x16x64_bf16 v[140:143], v[136:139], v[128:135], v13
    s_nop 7
    v_cvt_f64_f32 v[124:125], v140
    v_cvt_f64_f32 v[126:127], v141
    ds_add_f64 v10, v[124:125] offset:2560
    ds_add_f64 v10, v[126:127] offset:3072
    s_waitcnt lgkmcnt(0)
    s_barrier
L_t3:
    s_cmp_ge_u32 s84, 80
    s_cbranch_scc1 L_fb
    s_mov_b32 s92, 0x00030003
    s_mov_b32 s93, s92
X_41:
    s_waitcnt vmcnt(0)
    v_cmp_eq_u32 vcc, -1, v14
    s_cbranch_vccz XD_42
    s_sub_u32 s99, s99, 16
    s_cselect_b32 s99, 0, s99
    s_cbranch_scc1 XD_42
    s_mov_b64 exec, s[68:69]
    buffer_load_dword v14, v3, s[32:35], s87 offen sc1
    s_mov_b64 exec, -1
    s_branch X_41
XD_42:
    v_lshlrev_b32 v25, 16, v14
    v_and_b32 v24, 0xffff0000, v14
    v_cndmask_b32 v24, v24, v25, s[88:89]
    v_mov_b32 v21, s52
    v_mov_b64 v[28:29], 0
    v_mov_b64 v[30:31], 0
    s_cmp_ge_u32 s53, 27
    s_cbranch_scc1 L_nb
    s_barrier
L_nb:
    s_mov_b64 vcc, s[90:91]
S_43:
    s_mov_b64 exec, vcc
    buffer_load_dwordx2 v[28:29], v4, s[32:35], s83 offen sc1
    s_sub_u32 s99, s99, 16
    s_cselect_b32 s99, 0, s99
    s_cselect_b64 exec, 0, -1
    s_waitcnt vmcnt(0)
    v_max_u32 v7, v28, v29
    v_cmp_eq_u32 vcc, -1, v7
    s_mov_b64 exec, -1
    s_cbranch_vccnz S_43
    v_permlane32_swap_b32 v28, v29
    v_lshlrev_b32 v16, 16, v28
    v_and_b32 v17, 0xffff0000, v28
    v_lshlrev_b32 v18, 16, v29
    v_and_b32 v19, 0xffff0000, v29
    v_pk_add_f32 v[16:17], v[16:17], v[18:19]
    s_nop 1
    v_permlane16_swap_b32 v16, v17
    v_add_f32 v16, v16, v17
    v_fmac_f32 v24, v5, v16
    s_nop 1
    v_add_f32_dpp v24, v24, v24 row_ror:8 row_mask:0xf bank_mask:0xf
    s_nop 1
    v_add_f32_dpp v24, v24, v24 row_ror:4 row_mask:0xf bank_mask:0xf
    s_nop 1
    v_add_f32_dpp v24, v24, v24 row_ror:2 row_mask:0xf bank_mask:0xf
    s_mov_b64 exec, s[92:93]
    v_cvt_pk_bf16_f32 v24, v24, v24
    buffer_store_short v24, v2, s[56:59], 0 offen
    s_cmp_lg_u32 s84, 0
    s_cbranch_scc1 L_t3e
    s_mov_b64 exec, 1
    buffer_store_dword v21, v6, s[32:35], 0 offen
    s_mov_b64 exec, -1
L_t3e:
    s_endpgm
L_fb:
    s_cmp_ge_u32 s53, 27
    s_cbranch_scc1 L_fin
    s_barrier
    s_endpgm
L_cl:
    v_mul_u32_u24 v11, 1280, v14
    v_add_u32 v11, v11, v16
    v_xor_b32 v12, 32, v11
    v_add_u32 v12, 9216, v12
    s_sub_u32 s65, s53, 27
    s_lshl_b32 s63, s65, 1
    s_mov_b32 s74, s3
    s_movk_i32 s67, 3
    s_movk_i32 s50, 11
    s_movk_i32 s66, 2
    s_cmp_ge_u32 s3, 7
    s_cselect_b32 s72, 20, 0
    s_add_u32 s74, s74, s72
    s_lshl_b32 s75, s63, 10
    s_add_u32 s75, s75, 302336
    s_mul_i32 s71, s74, 163840
    s_lshl_b32 s72, s63, 7
    s_add_u32 s71, s71, s72
    s_add_u32 s62, s71, 81920
    s_add_u32 s69, s71, 128
    s_add_u32 s70, s62, 128
    s_cmp_eq_u32 s3, 11
    s_waitcnt lgkmcnt(0)
    s_load_dword s52, s[30:31], 0
    s_mov_b32 s56, s12
    s_mov_b32 s57, s13
    s_mov_b32 s58, 5242880
    s_mov_b32 s59, 0x20000
    s_cbranch_scc1 L_sv0
L_ls:
    s_add_u32 m0, s64, 4096
    s_nop 0
    buffer_load_dwordx4 v11, s[56:59], s69 offen nt lds
    buffer_load_dwordx4 v12, s[56:59], s69 offen offset:1024 nt lds
    s_add_u32 m0, s64, 6144
    s_nop 0
    buffer_load_dwordx4 v11, s[56:59], s71 offen nt lds
    buffer_load_dwordx4 v12, s[56:59], s71 offen offset:1024 nt lds
    s_cmp_eq_u32 s3, 11
    s_cbranch_scc1 L_sk2
    s_barrier
L_sk2:
    s_add_u32 m0, s64, 8192
    s_add_u32 s69, s69, 20480
    buffer_load_dwordx4 v11, s[56:59], s69 offen nt lds
    buffer_load_dwordx4 v12, s[56:59], s69 offen offset:1024 nt lds
    s_add_u32 m0, s64, 10240
    s_add_u32 s71, s71, 20480
    buffer_load_dwordx4 v11, s[56:59], s71 offen nt lds
    buffer_load_dwordx4 v12, s[56:59], s71 offen offset:1024 nt lds
    s_add_u32 m0, s64, 0
    s_add_u32 s69, s69, 20480
    buffer_load_dwordx4 v11, s[56:59], s69 offen nt lds
    buffer_load_dwordx4 v12, s[56:59], s69 offen offset:1024 nt lds
    v_bfe_u32 v16, v0, 2, 1
    v_mul_u32_u24 v16, 1056, v16
    v_lshl_add_u32 v16, v14, 7, v16
    v_and_b32 v17, 3, v0
    v_lshl_add_u32 v16, v17, 3, v16
    v_add3_u32 v2, v16, v15, s64
    v_xor_b32 v3, 32, v2
    v_xor_b32 v4, 64, v2
    v_xor_b32 v5, 96, v2
    v_and_b32 v13, 1, v0
    v_cmp_eq_u32 vcc, 1, v13
    v_mov_b32 v13, 0x44444444
    v_mov_b32 v17, 0x4444eeee
    v_cndmask_b32 v13, v13, v17, vcc
    v_bfe_u32 v17, v0, 3, 1
    v_mul_u32_u24 v17, 0xaaaa, v17
    v_lshl_add_u32 v13, v17, 16, v13
    s_mov_b32 s32, s30
    s_mov_b32 s33, s31
    s_mov_b32 s34, 660736
    s_mov_b32 s35, 0x20000
    s_cmp_eq_u32 s3, 11
    s_cbranch_scc1 L_skt
    s_waitcnt lgkmcnt(0)
    s_mul_i32 s52, s52, 0x5bd1e9c5
    s_add_u32 s52, s52, 0x6a09e6b7
L_skt:
    s_waitcnt vmcnt(8) lgkmcnt(0)
    ds_read_b64_tr_b16 v[40:41], v2 offset:4096
    ds_read_b64_tr_b16 v[48:49], v3 offset:4096
    ds_read_b64_tr_b16 v[56:57], v4 offset:4096
    ds_read_b64_tr_b16 v[64:65], v5 offset:4096
    s_add_u32 m0, s64, 2048
    s_add_u32 s71, s71, 20480
    buffer_load_dwordx4 v11, s[56:59], s71 offen nt lds
    buffer_load_dwordx4 v12, s[56:59], s71 offen offset:1024 nt lds
    s_waitcnt vmcnt(8) lgkmcnt(0)
    ds_read_b64_tr_b16 v[104:105], v2 offset:6144
    ds_read_b64_tr_b16 v[112:113], v3 offset:6144
    ds_read_b64_tr_b16 v[120:121], v4 offset:6144
    ds_read_b64_tr_b16 v[128:129], v5 offset:6144
    s_add_u32 m0, s64, 4096
    s_add_u32 s69, s69, 20480
    buffer_load_dwordx4 v11, s[56:59], s69 offen nt lds
    buffer_load_dwordx4 v12, s[56:59], s69 offen offset:1024 nt lds
    s_waitcnt vmcnt(8) lgkmcnt(0)
    ds_read_b64_tr_b16 v[42:43], v2 offset:8192
    ds_read_b64_tr_b16 v[50:51], v3 offset:8192
    ds_read_b64_tr_b16 v[58:59], v4 offset:8192
    ds_read_b64_tr_b16 v[66:67], v5 offset:8192
    s_add_u32 m0, s64, 6144
    s_add_u32 s71, s71, 20480
    buffer_load_dwordx4 v11, s[56:59], s71 offen nt lds
    buffer_load_dwordx4 v12, s[56:59], s71 offen offset:1024 nt lds
    s_waitcnt vmcnt(8) lgkmcnt(0)
    ds_read_b64_tr_b16 v[106:107], v2 offset:10240
    ds_read_b64_tr_b16 v[114:115], v3 offset:10240
    ds_read_b64_tr_b16 v[122:123], v4 offset:10240
    ds_read_b64_tr_b16 v[130:131], v5 offset:10240
    s_add_u32 m0, s64, 8192
    s_nop 0
    buffer_load_dwordx4 v11, s[56:59], s70 offen nt lds
    buffer_load_dwordx4 v12, s[56:59], s70 offen offset:1024 nt lds
    s_waitcnt vmcnt(8) lgkmcnt(0)
    ds_read_b64_tr_b16 v[44:45], v2 offset:0
    ds_read_b64_tr_b16 v[52:53], v3 offset:0
    ds_read_b64_tr_b16 v[60:61], v4 offset:0
    ds_read_b64_tr_b16 v[68:69], v5 offset:0
    s_add_u32 m0, s64, 10240
    s_nop 0
    buffer_load_dwordx4 v11, s[56:59], s62 offen nt lds
    buffer_load_dwordx4 v12, s[56:59], s62 offen offset:1024 nt lds
    s_waitcnt vmcnt(8) lgkmcnt(0)
    ds_read_b64_tr_b16 v[108:109], v2 offset:2048
    ds_read_b64_tr_b16 v[116:117], v3 offset:2048
    ds_read_b64_tr_b16 v[124:125], v4 offset:2048
    ds_read_b64_tr_b16 v[132:133], v5 offset:2048
    s_add_u32 m0, s64, 0
    s_add_u32 s70, s70, 20480
    buffer_load_dwordx4 v11, s[56:59], s70 offen nt lds
    buffer_load_dwordx4 v12, s[56:59], s70 offen offset:1024 nt lds
    s_waitcnt vmcnt(8) lgkmcnt(0)
    ds_read_b64_tr_b16 v[46:47], v2 offset:4096
    ds_read_b64_tr_b16 v[54:55], v3 offset:4096
    ds_read_b64_tr_b16 v[62:63], v4 offset:4096
    ds_read_b64_tr_b16 v[70:71], v5 offset:4096
    s_add_u32 m0, s64, 2048
    s_add_u32 s62, s62, 20480
    buffer_load_dwordx4 v11, s[56:59], s62 offen nt lds
    buffer_load_dwordx4 v12, s[56:59], s62 offen offset:1024 nt lds
    s_waitcnt vmcnt(8) lgkmcnt(0)
    ds_read_b64_tr_b16 v[110:111], v2 offset:6144
    ds_read_b64_tr_b16 v[118:119], v3 offset:6144
    ds_read_b64_tr_b16 v[126:127], v4 offset:6144
    ds_read_b64_tr_b16 v[134:135], v5 offset:6144
    s_add_u32 m0, s64, 4096
    s_add_u32 s70, s70, 20480
    buffer_load_dwordx4 v11, s[56:59], s70 offen nt lds
    buffer_load_dwordx4 v12, s[56:59], s70 offen offset:1024 nt lds
    s_waitcnt vmcnt(8) lgkmcnt(0)
    ds_read_b64_tr_b16 v[72:73], v2 offset:8192
    ds_read_b64_tr_b16 v[80:81], v3 offset:8192
    ds_read_b64_tr_b16 v[88:89], v4 offset:8192
    ds_read_b64_tr_b16 v[96:97], v5 offset:8192
    s_add_u32 m0, s64, 6144
    s_add_u32 s62, s62, 20480
    buffer_load_dwordx4 v11, s[56:59], s62 offen nt lds
    buffer_load_dwordx4 v12, s[56:59], s62 offen offset:1024 nt lds
    s_waitcnt vmcnt(8) lgkmcnt(0)
    ds_read_b64_tr_b16 v[136:137], v2 offset:10240
    ds_read_b64_tr_b16 v[144:145], v3 offset:10240
    ds_read_b64_tr_b16 v[152:153], v4 offset:10240
    ds_read_b64_tr_b16 v[160:161], v5 offset:10240
    s_add_u32 m0, s64, 8192
    s_add_u32 s70, s70, 20480
    buffer_load_dwordx4 v11, s[56:59], s70 offen nt lds
    buffer_load_dwordx4 v12, s[56:59], s70 offen offset:1024 nt lds
    s_waitcnt vmcnt(8) lgkmcnt(0)
    ds_read_b64_tr_b16 v[74:75], v2 offset:0
    ds_read_b64_tr_b16 v[82:83], v3 offset:0
    ds_read_b64_tr_b16 v[90:91], v4 offset:0
    ds_read_b64_tr_b16 v[98:99], v5 offset:0
    s_add_u32 m0, s64, 10240
    s_add_u32 s62, s62, 20480
    buffer_load_dwordx4 v11, s[56:59], s62 offen nt lds
    buffer_load_dwordx4 v12, s[56:59], s62 offen offset:1024 nt lds
    s_mov_b64 exec, 1
    v_mov_b32 v8, 1
    ds_add_u32 v6, v8 offset:0
    s_mov_b64 exec, -1
    v_lshlrev_b32 v12, 4, v0
    v_bfe_u32 v7, v0, 1, 3
    v_lshlrev_b32 v9, 8, v7
    v_bfe_u32 v7, v0, 0, 1
    v_lshl_add_u32 v9, v7, 6, v9
    v_bfe_u32 v7, v0, 4, 2
    v_lshl_add_u32 v9, v7, 4, v9
    s_cmp_eq_u32 s3, 0
    s_cbranch_scc1 L_svl
L_lo:
    s_mul_i32 s84, s3, 27
    s_add_u32 s84, s84, s53
    s_lshr_b32 s85, s84, 3
    s_lshl_b32 s85, s85, 5
    s_and_b32 s86, s84, 7
    s_add_u32 s85, s85, s86
    s_lshl_b32 s85, s85, 1
    v_and_b32 v24, 49, v0
    v_add_u32 v24, s85, v24
    v_min_u32 v24, 639, v24
    v_lshlrev_b32 v15, 3, v24
    s_lshl_b32 s49, s74, 7
    s_add_u32 s49, s49, 217088
    s_lshl_b32 s74, s74, 11
    s_add_u32 s74, s74, 236800
    s_mov_b32 s85, 60416
    s_mov_b32 s86, 80896
    v_and_b32 v14, 7, v0
    v_min_u32 v14, 6, v14
    v_lshlrev_b32 v14, 4, v14
    v_and_b32 v7, 7, v0
    v_cmp_eq_u32 s[70:71], 7, v7
    s_mov_b32 s92, 0x3fff3fff
    s_mov_b32 s93, s92
    v_mov_b64 v[16:17], 0
    v_mov_b64 v[18:19], 0
    v_mov_b64 v[20:21], 0
    v_mov_b64 v[22:23], 0
    buffer_load_dwordx4 v[28:31], v14, s[32:35], s49 offen sc1
    buffer_load_dwordx2 v[32:33], v15, s[32:35], s85 offen sc1
    buffer_load_dwordx2 v[34:35], v15, s[32:35], s86 offen sc1
W_45:
    ds_read_b32 v7, v6 offset:4
    s_waitcnt lgkmcnt(0)
    v_readfirstlane_b32 s98, v7
    s_cmp_ge_u32 s98, 1
    s_nop 2
    s_cbranch_scc1 WD_46
    s_sleep 1
    s_sub_u32 s99, s99, 1
    s_cbranch_scc0 W_45
    s_mov_b32 s99, 0
WD_46:
    s_lshr_b32 s73, s98, 1
    s_cselect_b64 s[76:77], -1, 0
    s_not_b64 s[78:79], s[76:77]
    v_bfe_u32 v7, v0, 3, 2
    v_lshlrev_b32 v10, 3, v7
    v_bfe_u32 v7, v0, 1, 2
    v_lshl_add_u32 v10, v7, 5, v10
    v_bfe_u32 v7, v0, 0, 1
    v_lshl_add_u32 v10, v7, 7, v10
    v_bfe_u32 v7, v0, 5, 1
    v_lshl_add_u32 v10, v7, 8, v10
    s_and_b32 s87, s63, 1
    s_lshl_b32 s88, s87, 9
    s_lshl_b32 s87, s87, 10
    v_add_u32 v10, s88, v10
    v_and_b32 v11, 0x1f0, v12
    v_add_u32 v11, s88, v11
    v_add_u32 v27, s64, v12
    v_add_u32 v12, s87, v12
    v_bfe_u32 v7, v0, 0, 3
    v_lshlrev_b32 v8, 2, v7
    v_bfe_u32 v7, v0, 4, 1
    v_lshl_add_u32 v8, v7, 5, v8
    v_bfe_u32 v7, v0, 3, 1
    v_lshl_add_u32 v8, v7, 6, v8
    v_bfe_u32 v7, v0, 0, 2
    v_lshlrev_b32 v25, 2, v7
    v_bfe_u32 v7, v0, 2, 4
    v_lshl_add_u32 v25, v7, 6, v25
    s_lshl_b32 s60, s67, 7
    s_lshl_b32 s61, s67, 4
    v_add_u32 v8, s60, v8
    v_add_u32 v25, s61, v25
    v_cmp_gt_u32 vcc, 32, v0
    s_nop 1
    v_cndmask_b32 v8, v25, v8, vcc
    s_lshl_b32 s80, s3, 10
    s_add_u32 s80, s80, 302336
    s_lshl_b32 s83, s84, 4
    s_add_u32 s83, s83, 312576
    s_mov_b32 s87, 302848
    s_mov_b32 s90, -1
    s_mov_b32 s91, 0x003fffff
    s_mov_b32 s94, 0x33333333
    s_mov_b32 s95, s94
    v_bfe_u32 v7, v24, 6, 4
    v_lshlrev_b32 v25, 10, v7
    v_bfe_u32 v7, v24, 2, 1
    v_lshl_add_u32 v25, v7, 6, v25
    v_bfe_u32 v7, v24, 0, 1
    v_lshl_add_u32 v25, v7, 7, v25
    v_bfe_u32 v7, v24, 5, 1
    v_lshl_add_u32 v25, v7, 8, v25
    v_bfe_u32 v7, v24, 4, 1
    v_lshl_add_u32 v25, v7, 2, v25
    v_bfe_u32 v7, v24, 1, 1
    v_lshl_add_u32 v25, v7, 3, v25
    v_bfe_u32 v7, v0, 1, 2
    v_lshl_add_u32 v25, v7, 4, v25
    v_lshrrev_b32 v26, 1, v0
    v_mul_u32_u24 v26, 1408, v26
    v_and_b32 v7, 1, v0
    v_lshl_add_u32 v26, v7, 3, v26
    v_and_b32 v7, 8, v24
    v_cmp_eq_u32 s[88:89], 0, v7
    v_lshlrev_b32 v24, 1, v24
    s_mov_b32 s56, s26
    s_mov_b32 s57, s27
    s_mov_b32 s58, 1280
    s_mov_b32 s59, 0x20000
    s_waitcnt vmcnt(11)
    ds_read_b64_tr_b16 v[138:139], v2 offset:2048
    ds_read_b64_tr_b16 v[146:147], v3 offset:2048
    ds_read_b64_tr_b16 v[154:155], v4 offset:2048
    ds_read_b64_tr_b16 v[162:163], v5 offset:2048
    s_waitcnt vmcnt(9)
    ds_read_b64_tr_b16 v[76:77], v2 offset:4096
    ds_read_b64_tr_b16 v[84:85], v3 offset:4096
    ds_read_b64_tr_b16 v[92:93], v4 offset:4096
    ds_read_b64_tr_b16 v[100:101], v5 offset:4096
    s_waitcnt vmcnt(7)
    ds_read_b64_tr_b16 v[140:141], v2 offset:6144
    ds_read_b64_tr_b16 v[148:149], v3 offset:6144
    ds_read_b64_tr_b16 v[156:157], v4 offset:6144
    ds_read_b64_tr_b16 v[164:165], v5 offset:6144
    s_waitcnt vmcnt(5)
    ds_read_b64_tr_b16 v[78:79], v2 offset:8192
    ds_read_b64_tr_b16 v[86:87], v3 offset:8192
    ds_read_b64_tr_b16 v[94:95], v4 offset:8192
    ds_read_b64_tr_b16 v[102:103], v5 offset:8192
    s_waitcnt vmcnt(3)
    ds_read_b64_tr_b16 v[142:143], v2 offset:10240
    ds_read_b64_tr_b16 v[150:151], v3 offset:10240
    ds_read_b64_tr_b16 v[158:159], v4 offset:10240
    ds_read_b64_tr_b16 v[166:167], v5 offset:10240
    s_waitcnt vmcnt(0)
    v_cmp_ne_u32 vcc, s52, v29
    v_cmp_ne_u32 s[96:97], s52, v31
    s_or_b64 vcc, vcc, s[96:97]
    v_cmp_ne_u32 s[96:97], s52, v33
    s_or_b64 vcc, vcc, s[96:97]
    v_cmp_ne_u32 s[96:97], s52, v35
    s_or_b64 vcc, vcc, s[96:97]
    s_cmp_eq_u64 vcc, 0
    s_nop 1
    s_cbranch_scc1 PD_48
W_49:
    ds_read_b32 v7, v6 offset:0
    s_waitcnt lgkmcnt(0)
    v_readfirstlane_b32 s98, v7
    s_cmp_ge_u32 s98, 10
    s_nop 2
    s_cbranch_scc1 WD_50
    s_sleep 1
    s_sub_u32 s99, s99, 1
    s_cbranch_scc0 W_49
    s_mov_b32 s99, 0
WD_50:
P_47:
    buffer_load_dwordx4 v[28:31], v14, s[32:35], s49 offen sc1
    buffer_load_dwordx2 v[32:33], v15, s[32:35], s85 offen sc1
    buffer_load_dwordx2 v[34:35], v15, s[32:35], s86 offen sc1
    s_waitcnt vmcnt(0)
    v_cmp_ne_u32 vcc, s52, v29
    v_cmp_ne_u32 s[96:97], s52, v31
    s_or_b64 vcc, vcc, s[96:97]
    v_cmp_ne_u32 s[96:97], s52, v33
    s_or_b64 vcc, vcc, s[96:97]
    v_cmp_ne_u32 s[96:97], s52, v35
    s_or_b64 vcc, vcc, s[96:97]
    s_cmp_eq_u64 vcc, 0
    s_nop 1
    s_cbranch_scc1 PD_48
    s_sleep 2
    s_sub_u32 s99, s99, 16
    s_cbranch_scc0 P_47
    s_mov_b32 s99, 0
PD_48:
    s_mov_b64 exec, s[92:93]
    buffer_load_dwordx4 v[16:19], v9, s[32:35], s74 offen sc1
    buffer_load_dwordx4 v[20:23], v9, s[32:35], s74 offen offset:128 sc1
    s_mov_b64 exec, -1
    s_cmp_lt_u32 s84, 80
    s_cselect_b32 s68, 0x00ff00ff, 0
    s_mov_b32 s69, s68
    s_mov_b32 s60, 0x0f0f0f0f
    s_mov_b32 s61, 0xf0f0f0f0
    v_mov_b32 v7, v27
    v_add_f32 v27, v32, v34
    v_cvt_pk_bf16_f32 v27, v27, v27
    v_and_b32 v27, 0xffff0000, v27
    ds_write_b128 v7, v[24:27] offset:1024
    v_mov_b32 v29, v28
    s_nop 1
    v_max_f32_dpp v29, v29, v29 row_half_mirror row_mask:0xf bank_mask:0xf
    s_nop 1
    v_max_f32_dpp v29, v29, v29 quad_perm:[1,0,3,2] row_mask:0xf bank_mask:0xf
    s_nop 1
    v_max_f32_dpp v29, v29, v29 quad_perm:[2,3,0,1] row_mask:0xf bank_mask:0xf
    v_sub_f32 v28, v28, v29
    v_mul_f32 v28, 0x3fb8aa3b, v28
    v_exp_f32 v28, v28
    s_nop 0
    v_cndmask_b32 v28, v28, 0, s[70:71]
    v_mul_f32 v29, v28, v30
    s_nop 1
    v_add_f32_dpp v29, v29, v29 row_half_mirror row_mask:0xf bank_mask:0xf
    s_nop 1
    v_add_f32_dpp v29, v29, v29 quad_perm:[1,0,3,2] row_mask:0xf bank_mask:0xf
    s_nop 1
    v_add_f32_dpp v29, v29, v29 quad_perm:[2,3,0,1] row_mask:0xf bank_mask:0xf
    v_rcp_f32 v29, v29
    s_nop 0
    v_mul_f32 v28, v28, v29
    v_cvt_pk_bf16_f32 v15, v28, v28
    v_mov_b32 v14, 0
    v_mov_b64 v[24:25], 0
    v_mov_b64 v[26:27], 0
    v_mov_b64 v[28:29], 0
    v_mov_b64 v[30:31], 0
    v_mov_b64 v[32:33], 0
    v_mov_b64 v[34:35], 0
    v_mov_b64 v[36:37], 0
    v_mov_b64 v[38:39], 0
    v_mov_b32_dpp v2, v15 row_newbcast:0 row_mask:5 bank_mask:0xf
    v_mov_b32_dpp v3, v15 row_newbcast:1 row_mask:5 bank_mask:0xf
    v_mov_b32_dpp v4, v15 row_newbcast:2 row_mask:5 bank_mask:0xf
    v_mov_b32_dpp v5, v15 row_newbcast:3 row_mask:5 bank_mask:0xf
    v_mov_b32_dpp v2, v15 row_newbcast:4 row_mask:10 bank_mask:0xf
    v_mov_b32_dpp v3, v15 row_newbcast:5 row_mask:10 bank_mask:0xf
    v_mov_b32_dpp v4, v15 row_newbcast:6 row_mask:10 bank_mask:0xf
    v_mov_b32_dpp v5, v15 row_newbcast:7 row_mask:10 bank_mask:0xf
    v_cndmask_b32 v2, 0, v2, s[60:61]
    v_cndmask_b32 v3, 0, v3, s[60:61]
    v_cndmask_b32 v4, 0, v4, s[60:61]
    v_cndmask_b32 v5, 0, v5, s[60:61]
    s_waitcnt lgkmcnt(0)
    s_waitcnt vmcnt(0)
    v_max3_u32 v7, v16, v17, v18
    v_max3_u32 v7, v19, v20, v7
    v_max3_u32 v7, v21, v22, v7
    v_max_u32 v7, v23, v7
    v_cmp_eq_u32 vcc, -1, v7
    s_cbranch_vccz SD_52
W_53:
    ds_read_b32 v7, v6 offset:0
    s_waitcnt lgkmcnt(0)
    v_readfirstlane_b32 s98, v7
    s_cmp_ge_u32 s98, 12
    s_nop 2
    s_cbranch_scc1 WD_54
    s_sleep 1
    s_sub_u32 s99, s99, 1
    s_cbranch_scc0 W_53
    s_mov_b32 s99, 0
WD_54:
S_51:
    s_mov_b64 exec, vcc
    buffer_load_dwordx4 v[16:19], v9, s[32:35], s74 offen sc1
    buffer_load_dwordx4 v[20:23], v9, s[32:35], s74 offen offset:128 sc1
    s_sub_u32 s99, s99, 16
    s_cselect_b32 s99, 0, s99
    s_cselect_b64 exec, 0, -1
    s_waitcnt vmcnt(0)
    v_max3_u32 v7, v16, v17, v18
    v_max3_u32 v7, v19, v20, v7
    v_max3_u32 v7, v21, v22, v7
    v_max_u32 v7, v23, v7
    v_cmp_eq_u32 vcc, -1, v7
    s_mov_b64 exec, -1
    s_cbranch_vccnz S_51
SD_52:
    v_smfmac_f32_16x16x64_bf16 v[24:27], v[16:19], v[40:47], v13
    s_nop 0
    ds_read_b128 v[40:43], v6 offset:64
    ds_read_b128 v[44:47], v6 offset:64
    v_smfmac_f32_16x16x64_bf16 v[24:27], v[20:23], v[72:79], v13
    s_nop 0
    ds_read_b128 v[72:75], v6 offset:64
    ds_read_b128 v[76:79], v6 offset:64
    v_smfmac_f32_16x16x64_bf16 v[28:31], v[16:19], v[48:55], v13
    s_nop 2
    v_smfmac_f32_16x16x64_bf16 v[28:31], v[20:23], v[80:87], v13
    s_nop 0
    ds_read_b32 v80, v6 offset:64
    v_cvt_pk_bf16_f32 v48, v24, v25
    v_smfmac_f32_16x16x64_bf16 v[32:35], v[16:19], v[56:63], v13
    s_nop 1
    v_cvt_pk_bf16_f32 v50, v26, v27
    v_smfmac_f32_16x16x64_bf16 v[32:35], v[20:23], v[88:95], v13
    s_nop 1
    v_cvt_pk_bf16_f32 v52, v28, v29
    v_smfmac_f32_16x16x64_bf16 v[36:39], v[16:19], v[64:71], v13
    s_nop 1
    v_cvt_pk_bf16_f32 v54, v30, v31
    v_smfmac_f32_16x16x64_bf16 v[36:39], v[20:23], v[96:103], v13
    s_nop 0
    s_waitcnt lgkmcnt(0)
    v_cvt_pk_bf16_f32 v49, v32, v33
    v_smfmac_f32_16x16x64_bf16 v[40:43], v[16:19], v[104:111], v13
    s_nop 0
    ds_read_b128 v[88:91], v12 offset:6656
    v_cvt_pk_bf16_f32 v51, v34, v35
    v_smfmac_f32_16x16x64_bf16 v[40:43], v[20:23], v[136:143], v13
    s_nop 0
    ds_read_b128 v[92:95], v12 offset:7680
    v_cvt_pk_bf16_f32 v53, v36, v37
    v_smfmac_f32_16x16x64_bf16 v[44:47], v[16:19], v[112:119], v13
    s_nop 1
    v_cvt_pk_bf16_f32 v55, v38, v39
    v_smfmac_f32_16x16x64_bf16 v[44:47], v[20:23], v[144:151], v13
    s_nop 1
    v_cvt_pk_bf16_f32 v56, v40, v41
    v_smfmac_f32_16x16x64_bf16 v[80:83], v[2:5], v[48:55], v13 abid:1
    s_nop 1
    v_cvt_pk_bf16_f32 v58, v42, v43
    v_smfmac_f32_16x16x64_bf16 v[72:75], v[16:19], v[120:127], v13
    s_nop 1
    v_cvt_pk_bf16_f32 v60, v44, v45
    v_smfmac_f32_16x16x64_bf16 v[72:75], v[20:23], v[152:159], v13
    s_nop 1
    v_cvt_pk_bf16_f32 v62, v46, v47
    v_smfmac_f32_16x16x64_bf16 v[76:79], v[16:19], v[128:135], v13
    s_nop 1
    v_cvt_f64_f32 v[84:85], v80
    v_smfmac_f32_16x16x64_bf16 v[76:79], v[20:23], v[160:167], v13
    s_nop 0
    ds_add_f64 v10, v[84:85] offset:768
    v_cvt_pk_bf16_f32 v57, v72, v73
    v_cvt_pk_bf16_f32 v59, v74, v75
    s_nop 3
    v_cvt_pk_bf16_f32 v61, v76, v77
    v_cvt_pk_bf16_f32 v63, v78, v79
    s_nop 1
    v_smfmac_f32_16x16x64_bf16 v[14:17], v[2:5], v[56:63], v13 abid:1
    s_nop 7
    v_cvt_f64_f32 v[18:19], v14
    ds_add_f64 v10, v[18:19] offset:256
    ds_inc_rtn_u32 v7, v10, v13 offset:1280
    ds_read_b128 v[20:23], v11 offset:256
    ds_read_b128 v[24:27], v11 offset:768
    v_lshl_add_u32 v15, v0, 4, s64
    s_waitcnt lgkmcnt(2)
    v_cmp_eq_u32 vcc, s50, v7
    s_waitcnt lgkmcnt(1)
    v_cvt_f32_f64 v20, v[20:21]
    v_cvt_f32_f64 v21, v[22:23]
    s_and_b64 s[76:77], vcc, s[76:77]
    s_and_b64 s[78:79], vcc, s[78:79]
    v_fma_f32 v20, v20, v88, v90
    v_fma_f32 v21, v21, v89, v91
    v_cvt_pk_bf16_f32 v20, v20, v21
    s_mov_b64 exec, s[76:77]
    buffer_store_dword v20, v8, s[32:35], s75 offen offset:0
    s_mov_b64 exec, -1
    s_waitcnt lgkmcnt(0)
    v_cvt_f32_f64 v24, v[24:25]
    v_cvt_f32_f64 v25, v[26:27]
    v_fma_f32 v24, v24, v92, v94
    v_fma_f32 v25, v25, v93, v95
    v_cvt_pk_bf16_f32 v24, v24, v25
    s_mov_b64 exec, s[76:77]
    buffer_store_dword v24, v8, s[32:35], s75 offen offset:1024
    s_mov_b64 exec, s[78:79]
    buffer_store_dword v20, v8, s[32:35], s75 offen offset:0 sc1
    buffer_store_dword v24, v8, s[32:35], s75 offen offset:1024 sc1
    s_mov_b64 exec, -1
    s_endpgm
    ds_read_b128 v[2:5], v15 offset:1024
    v_cndmask_b32 v14, 0, -1, s[68:69]
    s_waitcnt lgkmcnt(0)
    s_branch L_t3
L_cd:
    s_add_u32 m0, s64, 2048
    s_nop 0
    buffer_load_dwordx4 v9, s[40:43], s69 offen nt lds
    buffer_load_dwordx4 v10, s[40:43], s69 offen offset:1024 nt lds
    s_add_u32 m0, s64, 4096
    s_add_u32 s69, s69, 55296
    buffer_load_dwordx4 v9, s[40:43], s69 offen nt lds
    buffer_load_dwordx4 v10, s[40:43], s69 offen offset:1024 nt lds
    s_barrier
    s_add_u32 m0, s64, 6144
    s_add_u32 s69, s69, 55296
    buffer_load_dwordx4 v9, s[40:43], s69 offen nt lds
    buffer_load_dwordx4 v10, s[40:43], s69 offen offset:1024 nt lds
    s_add_u32 m0, s64, 8192
    s_add_u32 s69, s69, 55296
    buffer_load_dwordx4 v9, s[40:43], s69 offen nt lds
    buffer_load_dwordx4 v10, s[40:43], s69 offen offset:1024 nt lds
    v_mul_u32_u24 v11, 1280, v14
    v_add_u32 v11, v11, v16
    v_xor_b32 v12, 32, v11
    v_add_u32 v12, 9216, v12
    v_bfe_u32 v16, v0, 2, 1
    v_mul_u32_u24 v16, 1056, v16
    v_lshl_add_u32 v16, v14, 7, v16
    v_and_b32 v17, 3, v0
    v_lshl_add_u32 v16, v17, 3, v16
    v_add3_u32 v2, v16, v15, s64
    v_xor_b32 v3, 32, v2
    v_xor_b32 v4, 64, v2
    v_xor_b32 v5, 96, v2
    v_and_b32 v13, 1, v0
    v_cmp_eq_u32 vcc, 1, v13
    v_mov_b32 v13, 0x44444444
    v_mov_b32 v17, 0x4444eeee
    v_cndmask_b32 v13, v13, v17, vcc
    v_bfe_u32 v17, v0, 3, 1
    v_mul_u32_u24 v17, 0xaaaa, v17
    v_lshl_add_u32 v13, v17, 16, v13
    s_mov_b32 s32, s30
    s_mov_b32 s33, s31
    s_mov_b32 s34, 660736
    s_mov_b32 s35, 0x20000
    s_waitcnt lgkmcnt(0)
    s_mul_i32 s52, s52, 0x5bd1e9c5
    s_add_u32 s52, s52, 0x6a09e6b7
    s_mov_b32 s56, s20
    s_mov_b32 s57, s21
    s_mov_b32 s58, 2211840
    s_mov_b32 s59, 0x20000
    s_sub_u32 s68, s3, 8
    s_lshl_b32 s68, s68, 1
    s_mul_i32 s71, s53, 81920
    s_lshl_b32 s72, s68, 7
    s_add_u32 s71, s71, s72
    s_add_u32 s62, s71, 128
    s_waitcnt vmcnt(6) lgkmcnt(0)
    ds_read_b64_tr_b16 v[40:41], v2 offset:2048
    ds_read_b64_tr_b16 v[48:49], v3 offset:2048
    ds_read_b64_tr_b16 v[56:57], v4 offset:2048
    ds_read_b64_tr_b16 v[64:65], v5 offset:2048
    s_add_u32 m0, s64, 10240
    s_nop 0
    buffer_load_dwordx4 v9, s[44:47], s70 offen nt lds
    buffer_load_dwordx4 v10, s[44:47], s70 offen offset:1024 nt lds
    s_waitcnt vmcnt(6) lgkmcnt(0)
    ds_read_b64_tr_b16 v[42:43], v2 offset:4096
    ds_read_b64_tr_b16 v[50:51], v3 offset:4096
    ds_read_b64_tr_b16 v[58:59], v4 offset:4096
    ds_read_b64_tr_b16 v[66:67], v5 offset:4096
    s_add_u32 m0, s64, 2048
    s_add_u32 s70, s70, 55296
    buffer_load_dwordx4 v9, s[44:47], s70 offen nt lds
    buffer_load_dwordx4 v10, s[44:47], s70 offen offset:1024 nt lds
    s_waitcnt vmcnt(6) lgkmcnt(0)
    ds_read_b64_tr_b16 v[44:45], v2 offset:6144
    ds_read_b64_tr_b16 v[52:53], v3 offset:6144
    ds_read_b64_tr_b16 v[60:61], v4 offset:6144
    ds_read_b64_tr_b16 v[68:69], v5 offset:6144
    s_add_u32 m0, s64, 4096
    s_add_u32 s70, s70, 55296
    buffer_load_dwordx4 v9, s[44:47], s70 offen nt lds
    buffer_load_dwordx4 v10, s[44:47], s70 offen offset:1024 nt lds
    s_waitcnt vmcnt(6) lgkmcnt(0)
    ds_read_b64_tr_b16 v[46:47], v2 offset:8192
    ds_read_b64_tr_b16 v[54:55], v3 offset:8192
    ds_read_b64_tr_b16 v[62:63], v4 offset:8192
    ds_read_b64_tr_b16 v[70:71], v5 offset:8192
    s_add_u32 m0, s64, 6144
    s_add_u32 s70, s70, 55296
    buffer_load_dwordx4 v9, s[44:47], s70 offen nt lds
    buffer_load_dwordx4 v10, s[44:47], s70 offen offset:1024 nt lds
    s_waitcnt vmcnt(6) lgkmcnt(0)
    ds_read_b64_tr_b16 v[72:73], v2 offset:10240
    ds_read_b64_tr_b16 v[80:81], v3 offset:10240
    ds_read_b64_tr_b16 v[88:89], v4 offset:10240
    ds_read_b64_tr_b16 v[96:97], v5 offset:10240
    s_add_u32 m0, s64, 8192
    s_nop 0
    buffer_load_dwordx4 v11, s[56:59], s71 offen nt lds
    buffer_load_dwordx4 v12, s[56:59], s71 offen offset:1024 nt lds
    s_waitcnt vmcnt(6) lgkmcnt(0)
    ds_read_b64_tr_b16 v[74:75], v2 offset:2048
    ds_read_b64_tr_b16 v[82:83], v3 offset:2048
    ds_read_b64_tr_b16 v[90:91], v4 offset:2048
    ds_read_b64_tr_b16 v[98:99], v5 offset:2048
    s_add_u32 m0, s64, 10240
    s_nop 0
    buffer_load_dwordx4 v11, s[56:59], s62 offen nt lds
    buffer_load_dwordx4 v12, s[56:59], s62 offen offset:1024 nt lds
    s_waitcnt vmcnt(6) lgkmcnt(0)
    ds_read_b64_tr_b16 v[76:77], v2 offset:4096
    ds_read_b64_tr_b16 v[84:85], v3 offset:4096
    ds_read_b64_tr_b16 v[92:93], v4 offset:4096
    ds_read_b64_tr_b16 v[100:101], v5 offset:4096
    s_add_u32 m0, s64, 2048
    s_add_u32 s71, s71, 20480
    buffer_load_dwordx4 v11, s[56:59], s71 offen nt lds
    buffer_load_dwordx4 v12, s[56:59], s71 offen offset:1024 nt lds
    s_waitcnt vmcnt(6) lgkmcnt(0)
    ds_read_b64_tr_b16 v[78:79], v2 offset:6144
    ds_read_b64_tr_b16 v[86:87], v3 offset:6144
    ds_read_b64_tr_b16 v[94:95], v4 offset:6144
    ds_read_b64_tr_b16 v[102:103], v5 offset:6144
    s_add_u32 m0, s64, 4096
    s_add_u32 s62, s62, 20480
    buffer_load_dwordx4 v11, s[56:59], s62 offen nt lds
    buffer_load_dwordx4 v12, s[56:59], s62 offen offset:1024 nt lds
    v_bfe_u32 v7, v0, 0, 2
    v_lshlrev_b32 v14, 6, v7
    v_bfe_u32 v7, v0, 4, 2
    v_lshl_add_u32 v14, v7, 4, v14
    s_lshl_b32 s84, s3, 8
    v_add_u32 v14, s84, v14
    v_lshl_add_u32 v15, v0, 4, s64
W_55:
    ds_read_b32 v7, v6 offset:4
    s_waitcnt lgkmcnt(0)
    v_readfirstlane_b32 s98, v7
    s_cmp_ge_u32 s98, 1
    s_nop 2
    s_cbranch_scc1 WD_56
    s_sleep 1
    s_sub_u32 s99, s99, 1
    s_cbranch_scc0 W_55
    s_mov_b32 s99, 0
WD_56:
    s_lshr_b32 s73, s98, 1
    s_cselect_b64 s[76:77], -1, 0
    s_not_b64 s[78:79], s[76:77]
    ds_read_b128 v[16:19], v14 offset:8704
    v_mov_b64 v[24:25], 0
    v_mov_b64 v[26:27], 0
    v_mov_b64 v[28:29], 0
    v_mov_b64 v[30:31], 0
    v_mov_b64 v[32:33], 0
    v_mov_b64 v[34:35], 0
    v_mov_b64 v[36:37], 0
    v_mov_b64 v[38:39], 0
    s_waitcnt lgkmcnt(0)
    v_smfmac_f32_16x16x64_bf16 v[24:27], v[16:19], v[40:47], v13
    v_smfmac_f32_16x16x64_bf16 v[28:31], v[16:19], v[48:55], v13
    v_smfmac_f32_16x16x64_bf16 v[32:35], v[16:19], v[56:63], v13
    v_smfmac_f32_16x16x64_bf16 v[36:39], v[16:19], v[64:71], v13
    s_nop 4
    v_add_f32_dpp v20, v24, v25 quad_perm:[0,1,2,3] row_mask:1 bank_mask:0xf
    v_add_f32_dpp v22, v26, v27 quad_perm:[0,1,2,3] row_mask:1 bank_mask:0xf
    s_nop 0
    v_add_f32_dpp v20, v28, v29 quad_perm:[0,1,2,3] row_mask:2 bank_mask:0xf
    v_add_f32_dpp v22, v30, v31 quad_perm:[0,1,2,3] row_mask:2 bank_mask:0xf
    s_nop 0
    v_add_f32_dpp v20, v32, v33 quad_perm:[0,1,2,3] row_mask:4 bank_mask:0xf
    v_add_f32_dpp v22, v34, v35 quad_perm:[0,1,2,3] row_mask:4 bank_mask:0xf
    s_nop 0
    v_add_f32_dpp v20, v36, v37 quad_perm:[0,1,2,3] row_mask:8 bank_mask:0xf
    v_add_f32_dpp v22, v38, v39 quad_perm:[0,1,2,3] row_mask:8 bank_mask:0xf
    v_mov_b64 v[24:25], 0
    v_mov_b64 v[26:27], 0
    v_mov_b64 v[28:29], 0
    v_mov_b64 v[30:31], 0
    v_mov_b64 v[32:33], 0
    v_mov_b64 v[34:35], 0
    v_mov_b64 v[36:37], 0
    v_mov_b64 v[38:39], 0
    s_waitcnt lgkmcnt(0)
    v_smfmac_f32_16x16x64_bf16 v[24:27], v[16:19], v[72:79], v13
    v_smfmac_f32_16x16x64_bf16 v[28:31], v[16:19], v[80:87], v13
    v_smfmac_f32_16x16x64_bf16 v[32:35], v[16:19], v[88:95], v13
    v_smfmac_f32_16x16x64_bf16 v[36:39], v[16:19], v[96:103], v13
    s_nop 4
    v_add_f32_dpp v21, v24, v25 quad_perm:[0,1,2,3] row_mask:1 bank_mask:0xf
    v_add_f32_dpp v23, v26, v27 quad_perm:[0,1,2,3] row_mask:1 bank_mask:0xf
    s_nop 0
    v_add_f32_dpp v21, v28, v29 quad_perm:[0,1,2,3] row_mask:2 bank_mask:0xf
    v_add_f32_dpp v23, v30, v31 quad_perm:[0,1,2,3] row_mask:2 bank_mask:0xf
    s_nop 0
    v_add_f32_dpp v21, v32, v33 quad_perm:[0,1,2,3] row_mask:4 bank_mask:0xf
    v_add_f32_dpp v23, v34, v35 quad_perm:[0,1,2,3] row_mask:4 bank_mask:0xf
    s_nop 0
    v_add_f32_dpp v21, v36, v37 quad_perm:[0,1,2,3] row_mask:8 bank_mask:0xf
    v_add_f32_dpp v23, v38, v39 quad_perm:[0,1,2,3] row_mask:8 bank_mask:0xf
    ds_write_b128 v15, v[20:23]
    s_mov_b64 exec, 1
    v_mov_b32 v8, 1
    ds_add_u32 v6, v8 offset:8
    s_mov_b64 exec, -1
    s_waitcnt vmcnt(6) lgkmcnt(0)
    ds_read_b64_tr_b16 v[104:105], v2 offset:8192
    ds_read_b64_tr_b16 v[112:113], v3 offset:8192
    ds_read_b64_tr_b16 v[120:121], v4 offset:8192
    ds_read_b64_tr_b16 v[128:129], v5 offset:8192
    s_add_u32 m0, s64, 6144
    s_add_u32 s71, s71, 20480
    buffer_load_dwordx4 v11, s[56:59], s71 offen nt lds
    buffer_load_dwordx4 v12, s[56:59], s71 offen offset:1024 nt lds
    s_waitcnt vmcnt(6) lgkmcnt(0)
    ds_read_b64_tr_b16 v[136:137], v2 offset:10240
    ds_read_b64_tr_b16 v[144:145], v3 offset:10240
    ds_read_b64_tr_b16 v[152:153], v4 offset:10240
    ds_read_b64_tr_b16 v[160:161], v5 offset:10240
    s_add_u32 m0, s64, 8192
    s_add_u32 s62, s62, 20480
    buffer_load_dwordx4 v11, s[56:59], s62 offen nt lds
    buffer_load_dwordx4 v12, s[56:59], s62 offen offset:1024 nt lds
    s_waitcnt vmcnt(6) lgkmcnt(0)
    ds_read_b64_tr_b16 v[106:107], v2 offset:2048
    ds_read_b64_tr_b16 v[114:115], v3 offset:2048
    ds_read_b64_tr_b16 v[122:123], v4 offset:2048
    ds_read_b64_tr_b16 v[130:131], v5 offset:2048
    s_add_u32 m0, s64, 10240
    s_add_u32 s71, s71, 20480
    buffer_load_dwordx4 v11, s[56:59], s71 offen nt lds
    buffer_load_dwordx4 v12, s[56:59], s71 offen offset:1024 nt lds
    s_waitcnt vmcnt(6) lgkmcnt(0)
    ds_read_b64_tr_b16 v[138:139], v2 offset:4096
    ds_read_b64_tr_b16 v[146:147], v3 offset:4096
    ds_read_b64_tr_b16 v[154:155], v4 offset:4096
    ds_read_b64_tr_b16 v[162:163], v5 offset:4096
    s_add_u32 m0, s64, 2048
    s_add_u32 s62, s62, 20480
    buffer_load_dwordx4 v11, s[56:59], s62 offen nt lds
    buffer_load_dwordx4 v12, s[56:59], s62 offen offset:1024 nt lds
    s_mov_b64 exec, 1
    v_mov_b32 v8, 1
    ds_add_u32 v6, v8 offset:0
    s_mov_b64 exec, -1
    v_lshlrev_b32 v12, 4, v0
    v_bfe_u32 v7, v0, 1, 3
    v_lshlrev_b32 v9, 8, v7
    v_bfe_u32 v7, v0, 0, 1
    v_lshl_add_u32 v9, v7, 6, v9
    v_bfe_u32 v7, v0, 4, 2
    v_lshl_add_u32 v9, v7, 4, v9
    s_lshl_b32 s80, s3, 10
    s_add_u32 s80, s80, 302336
    s_mov_b32 s94, 0x33333333
    s_mov_b32 s95, s94
    v_bfe_u32 v7, v0, 5, 1
    v_lshlrev_b32 v12, 7, v7
    v_bfe_u32 v7, v0, 2, 1
    v_lshl_add_u32 v12, v7, 6, v12
    v_bfe_u32 v7, v0, 1, 1
    v_lshl_add_u32 v12, v7, 5, v12
    v_bfe_u32 v7, v0, 3, 2
    v_lshl_add_u32 v12, v7, 3, v12
    v_bfe_u32 v7, v0, 0, 1
    v_lshl_add_u32 v12, v7, 2, v12
    s_mul_i32 s83, s53, 1408
    s_lshl_b32 s84, s68, 7
    s_add_u32 s83, s83, s84
    s_add_u32 s83, s83, 312448
    s_mov_b32 s93, 0xbdd2d3e8
    s_waitcnt vmcnt(6)
    ds_read_b64_tr_b16 v[108:109], v2 offset:6144
    ds_read_b64_tr_b16 v[116:117], v3 offset:6144
    ds_read_b64_tr_b16 v[124:125], v4 offset:6144
    ds_read_b64_tr_b16 v[132:133], v5 offset:6144
    s_waitcnt vmcnt(4)
    ds_read_b64_tr_b16 v[140:141], v2 offset:8192
    ds_read_b64_tr_b16 v[148:149], v3 offset:8192
    ds_read_b64_tr_b16 v[156:157], v4 offset:8192
    ds_read_b64_tr_b16 v[164:165], v5 offset:8192
    s_waitcnt vmcnt(2)
    ds_read_b64_tr_b16 v[110:111], v2 offset:10240
    ds_read_b64_tr_b16 v[118:119], v3 offset:10240
    ds_read_b64_tr_b16 v[126:127], v4 offset:10240
    ds_read_b64_tr_b16 v[134:135], v5 offset:10240
    s_waitcnt vmcnt(0)
    ds_read_b64_tr_b16 v[142:143], v2 offset:2048
    ds_read_b64_tr_b16 v[150:151], v3 offset:2048
    ds_read_b64_tr_b16 v[158:159], v4 offset:2048
    ds_read_b64_tr_b16 v[166:167], v5 offset:2048
    s_setprio 2
    v_lshlrev_b32 v3, 2, v12
    v_add_u32 v3, 151552, v3
    v_lshlrev_b32 v12, 1, v12
    v_cmp_gt_u32 vcc, 16, v0
    v_lshlrev_b32 v2, 3, v0
    v_bfrev_b32 v7, 1
    v_cndmask_b32 v2, v7, v2, vcc
    v_mov_b32 v5, 0xc0135761
    buffer_load_dword v4, v2, s[32:35], s83 offen offset:128 sc1
    buffer_load_dword v4, v2, s[32:35], s83 offen offset:256 sc1
    v_mov_b64 v[16:17], 0
    v_mov_b64 v[18:19], 0
    v_bfe_u32 v7, v0, 2, 2
    v_lshlrev_b32 v14, 7, v7
    v_bfe_u32 v7, v0, 0, 1
    v_lshl_add_u32 v14, v7, 6, v14
    v_bfe_u32 v7, v0, 4, 2
    v_lshl_add_u32 v14, v7, 4, v14
    v_mov_b64 v[20:21], 0
    v_mov_b64 v[24:25], 0
    v_mov_b64 v[28:29], 0
    v_mov_b64 v[32:33], 0
    v_mov_b64 v[36:37], 0
    v_mov_b32 v7, 0x3f803f80
    s_mov_b32 s60, 0x000f000f
    s_mov_b32 s61, 0x0f000f00
    s_lshl_b64 s[62:63], s[60:61], 4
    v_lshlrev_b32 v15, 3, v0
    v_cndmask_b32 v8, 0, v7, s[60:61]
    v_cndmask_b32 v9, 0, v7, s[62:63]
    v_cndmask_b32 v10, 0, v7, s[60:61]
    v_cndmask_b32 v11, 0, v7, s[62:63]
    s_barrier
    s_mov_b64 vcc, s[94:95]
S_57:
    s_mov_b64 exec, vcc
    buffer_load_dwordx4 v[16:19], v14, s[32:35], s80 offen sc1
    s_sub_u32 s99, s99, 16
    s_cselect_b32 s99, 0, s99
    s_cselect_b64 exec, 0, -1
    s_waitcnt vmcnt(0)
    v_max3_u32 v7, v16, v17, v18
    v_max_u32 v7, v19, v7
    v_cmp_eq_u32 vcc, -1, v7
    s_mov_b64 exec, -1
    s_cbranch_vccnz S_57
    v_smfmac_f32_16x16x64_bf16 v[20:23], v[16:19], v[72:79], v13
    s_nop 2
    v_smfmac_f32_16x16x64_bf16 v[24:27], v[16:19], v[80:87], v13
    s_nop 0
    ds_read_b64 v[80:81], v6 offset:64
    ds_read_b64 v[84:85], v6 offset:64
    v_smfmac_f32_16x16x64_bf16 v[28:31], v[16:19], v[88:95], v13
    ds_read_b64 v[88:89], v6 offset:64
    ds_read_b64 v[92:93], v6 offset:64
    v_cvt_pk_bf16_f32 v73, v20, v21
    v_smfmac_f32_16x16x64_bf16 v[32:35], v[16:19], v[96:103], v13
    s_nop 1
    v_cvt_pk_bf16_f32 v75, v24, v25
    v_smfmac_f32_16x16x64_bf16 v[36:39], v[16:19], v[40:47], v13
    s_nop 0
    s_waitcnt lgkmcnt(0)
    v_cvt_pk_bf16_f32 v77, v28, v29
    v_smfmac_f32_16x16x64_bf16 v[80:83], v[16:19], v[48:55], v13
    ds_read_b64 v[40:41], v6 offset:64
    ds_read_b64 v[44:45], v6 offset:64
    v_cvt_pk_bf16_f32 v79, v32, v33
    v_smfmac_f32_16x16x64_bf16 v[84:87], v[16:19], v[56:63], v13
    ds_read_b64 v[48:49], v6 offset:64
    ds_read_b64 v[52:53], v6 offset:64
    v_cvt_pk_bf16_f32 v72, v36, v37
    v_smfmac_f32_16x16x64_bf16 v[88:91], v[16:19], v[64:71], v13
    ds_read_b64 v[56:57], v6 offset:64
    ds_read_b64 v[60:61], v6 offset:64
    v_cvt_pk_bf16_f32 v74, v80, v81
    ds_read_b64 v[64:65], v6 offset:64
    ds_read_b64 v[68:69], v6 offset:64
    v_cvt_pk_bf16_f32 v76, v84, v85
    s_nop 1
    v_cvt_pk_bf16_f32 v78, v88, v89
    s_nop 1
    v_smfmac_f32_16x16x64_bf16 v[92:95], v[8:11], v[72:79], v13
    s_nop 7
    v_cvt_f64_f32 v[16:17], v92
    v_cvt_f64_f32 v[18:19], v93
    ds_add_f64 v15, v[16:17] offset:2560
    ds_add_f64 v15, v[18:19] offset:3072
    s_branch L_s2
L_ce:
    v_mul_u32_u24 v11, 1280, v14
    v_add_u32 v11, v11, v16
    v_xor_b32 v12, 32, v11
    v_add_u32 v12, 9216, v12
    s_mul_i32 s65, s53, 205
    s_lshr_b32 s65, s65, 10
    s_mul_i32 s66, s65, 5
    s_sub_u32 s66, s53, s66
    s_lshr_b32 s63, s66, 1
    s_and_b32 s67, s66, 1
    s_lshl3_add_u32 s74, s67, s3
    s_add_u32 s74, s74, 7
    s_movk_i32 s50, 7
    s_bfe_u32 s68, s3, 0x10002
    s_and_b32 s72, s3, 3
    s_add_u32 s72, s72, 23
    s_cmp_eq_u32 s66, 4
    s_cmov_b32 s63, s68
    s_cmov_b32 s74, s72
    s_cmovk_i32 s67, 2
    s_cmovk_i32 s50, 3
    s_lshl1_add_u32 s63, s65, s63
    s_cmp_ge_u32 s53, 25
    s_cmovk_i32 s63, 0
    s_cmovk_i32 s65, 0
    s_cselect_b32 s66, 0, 1
    s_lshl_b32 s75, s63, 10
    s_add_u32 s75, s75, 302336
    s_mul_i32 s68, s3, 3
    s_sub_u32 s68, s68, 25
    s_mul_i32 s71, s53, 81920
    s_lshl_b32 s72, s68, 7
    s_add_u32 s71, s71, s72
    s_add_u32 s62, s71, 128
    s_sub_u32 s70, s71, 128
    s_cmp_eq_u32 s3, 11
    s_waitcnt lgkmcnt(0)
    s_load_dword s52, s[30:31], 0
    s_mov_b32 s56, s20
    s_mov_b32 s57, s21
    s_mov_b32 s58, 2211840
    s_mov_b32 s59, 0x20000
    s_cbranch_scc1 L_sv0
    s_barrier
    v_bfe_u32 v16, v0, 2, 1
    v_mul_u32_u24 v16, 1056, v16
    v_lshl_add_u32 v16, v14, 7, v16
    v_and_b32 v17, 3, v0
    v_lshl_add_u32 v16, v17, 3, v16
    v_add3_u32 v2, v16, v15, s64
    v_xor_b32 v3, 32, v2
    v_xor_b32 v4, 64, v2
    v_xor_b32 v5, 96, v2
    v_and_b32 v13, 1, v0
    v_cmp_eq_u32 vcc, 1, v13
    v_mov_b32 v13, 0x44444444
    v_mov_b32 v17, 0x4444eeee
    v_cndmask_b32 v13, v13, v17, vcc
    v_bfe_u32 v17, v0, 3, 1
    v_mul_u32_u24 v17, 0xaaaa, v17
    v_lshl_add_u32 v13, v17, 16, v13
    s_mov_b32 s32, s30
    s_mov_b32 s33, s31
    s_mov_b32 s34, 660736
    s_mov_b32 s35, 0x20000
    s_waitcnt lgkmcnt(0)
    s_mul_i32 s52, s52, 0x5bd1e9c5
    s_add_u32 s52, s52, 0x6a09e6b7
L_e0:
    s_add_u32 m0, s64, 10240
    s_nop 0
    buffer_load_dwordx4 v11, s[56:59], s70 offen nt lds
    buffer_load_dwordx4 v12, s[56:59], s70 offen offset:1024 nt lds
    s_add_u32 m0, s64, 0
    s_nop 0
    buffer_load_dwordx4 v11, s[56:59], s71 offen nt lds
    buffer_load_dwordx4 v12, s[56:59], s71 offen offset:1024 nt lds
    s_add_u32 m0, s64, 2048
    s_nop 0
    buffer_load_dwordx4 v11, s[56:59], s62 offen nt lds
    buffer_load_dwordx4 v12, s[56:59], s62 offen offset:1024 nt lds
    s_add_u32 m0, s64, 4096
    s_add_u32 s70, s70, 20480
    buffer_load_dwordx4 v11, s[56:59], s70 offen nt lds
    buffer_load_dwordx4 v12, s[56:59], s70 offen offset:1024 nt lds
    s_waitcnt vmcnt(6) lgkmcnt(0)
    ds_read_b64_tr_b16 v[72:73], v2 offset:10240
    ds_read_b64_tr_b16 v[80:81], v3 offset:10240
    ds_read_b64_tr_b16 v[88:89], v4 offset:10240
    ds_read_b64_tr_b16 v[96:97], v5 offset:10240
    s_add_u32 m0, s64, 6144
    s_add_u32 s71, s71, 20480
    buffer_load_dwordx4 v11, s[56:59], s71 offen nt lds
    buffer_load_dwordx4 v12, s[56:59], s71 offen offset:1024 nt lds
    s_waitcnt vmcnt(6) lgkmcnt(0)
    ds_read_b64_tr_b16 v[104:105], v2 offset:0
    ds_read_b64_tr_b16 v[112:113], v3 offset:0
    ds_read_b64_tr_b16 v[120:121], v4 offset:0
    ds_read_b64_tr_b16 v[128:129], v5 offset:0
    s_add_u32 m0, s64, 8192
    s_add_u32 s62, s62, 20480
    buffer_load_dwordx4 v11, s[56:59], s62 offen nt lds
    buffer_load_dwordx4 v12, s[56:59], s62 offen offset:1024 nt lds
    s_waitcnt vmcnt(6) lgkmcnt(0)
    ds_read_b64_tr_b16 v[136:137], v2 offset:2048
    ds_read_b64_tr_b16 v[144:145], v3 offset:2048
    ds_read_b64_tr_b16 v[152:153], v4 offset:2048
    ds_read_b64_tr_b16 v[160:161], v5 offset:2048
    s_add_u32 m0, s64, 10240
    s_add_u32 s70, s70, 20480
    buffer_load_dwordx4 v11, s[56:59], s70 offen nt lds
    buffer_load_dwordx4 v12, s[56:59], s70 offen offset:1024 nt lds
    s_waitcnt vmcnt(6) lgkmcnt(0)
    ds_read_b64_tr_b16 v[74:75], v2 offset:4096
    ds_read_b64_tr_b16 v[82:83], v3 offset:4096
    ds_read_b64_tr_b16 v[90:91], v4 offset:4096
    ds_read_b64_tr_b16 v[98:99], v5 offset:4096
    s_add_u32 m0, s64, 0
    s_add_u32 s71, s71, 20480
    buffer_load_dwordx4 v11, s[56:59], s71 offen nt lds
    buffer_load_dwordx4 v12, s[56:59], s71 offen offset:1024 nt lds
    s_waitcnt vmcnt(6) lgkmcnt(0)
    ds_read_b64_tr_b16 v[106:107], v2 offset:6144
    ds_read_b64_tr_b16 v[114:115], v3 offset:6144
    ds_read_b64_tr_b16 v[122:123], v4 offset:6144
    ds_read_b64_tr_b16 v[130:131], v5 offset:6144
    s_add_u32 m0, s64, 2048
    s_add_u32 s62, s62, 20480
    buffer_load_dwordx4 v11, s[56:59], s62 offen nt lds
    buffer_load_dwordx4 v12, s[56:59], s62 offen offset:1024 nt lds
    s_waitcnt vmcnt(6) lgkmcnt(0)
    ds_read_b64_tr_b16 v[138:139], v2 offset:8192
    ds_read_b64_tr_b16 v[146:147], v3 offset:8192
    ds_read_b64_tr_b16 v[154:155], v4 offset:8192
    ds_read_b64_tr_b16 v[162:163], v5 offset:8192
    s_add_u32 m0, s64, 4096
    s_add_u32 s70, s70, 20480
    buffer_load_dwordx4 v11, s[56:59], s70 offen nt lds
    buffer_load_dwordx4 v12, s[56:59], s70 offen offset:1024 nt lds
    s_waitcnt vmcnt(6) lgkmcnt(0)
    ds_read_b64_tr_b16 v[76:77], v2 offset:10240
    ds_read_b64_tr_b16 v[84:85], v3 offset:10240
    ds_read_b64_tr_b16 v[92:93], v4 offset:10240
    ds_read_b64_tr_b16 v[100:101], v5 offset:10240
    s_add_u32 m0, s64, 6144
    s_add_u32 s71, s71, 20480
    buffer_load_dwordx4 v11, s[56:59], s71 offen nt lds
    buffer_load_dwordx4 v12, s[56:59], s71 offen offset:1024 nt lds
    s_waitcnt vmcnt(6) lgkmcnt(0)
    ds_read_b64_tr_b16 v[108:109], v2 offset:0
    ds_read_b64_tr_b16 v[116:117], v3 offset:0
    ds_read_b64_tr_b16 v[124:125], v4 offset:0
    ds_read_b64_tr_b16 v[132:133], v5 offset:0
    s_add_u32 m0, s64, 8192
    s_add_u32 s62, s62, 20480
    buffer_load_dwordx4 v11, s[56:59], s62 offen nt lds
    buffer_load_dwordx4 v12, s[56:59], s62 offen offset:1024 nt lds
    s_mov_b64 exec, 1
    v_mov_b32 v8, 1
    ds_add_u32 v6, v8 offset:0
    s_mov_b64 exec, -1
    v_lshlrev_b32 v12, 4, v0
    v_bfe_u32 v7, v0, 1, 3
    v_lshlrev_b32 v9, 8, v7
    v_bfe_u32 v7, v0, 0, 1
    v_lshl_add_u32 v9, v7, 6, v9
    v_bfe_u32 v7, v0, 4, 2
    v_lshl_add_u32 v9, v7, 4, v9
W_59:
    ds_read_b32 v7, v6 offset:4
    s_waitcnt lgkmcnt(0)
    v_readfirstlane_b32 s98, v7
    s_cmp_ge_u32 s98, 1
    s_nop 2
    s_cbranch_scc1 WD_60
    s_sleep 1
    s_sub_u32 s99, s99, 1
    s_cbranch_scc0 W_59
    s_mov_b32 s99, 0
WD_60:
    s_lshr_b32 s73, s98, 1
    s_cselect_b64 s[76:77], -1, 0
    s_not_b64 s[78:79], s[76:77]
    s_cmp_lg_u32 s3, 11
    s_cbranch_scc1 L_e1
W_61:
    ds_read_b32 v7, v6 offset:8
    s_waitcnt lgkmcnt(0)
    v_readfirstlane_b32 s98, v7
    s_cmp_ge_u32 s98, 10
    s_nop 2
    s_cbranch_scc1 WD_62
    s_sleep 1
    s_sub_u32 s99, s99, 1
    s_cbranch_scc0 W_61
    s_mov_b32 s99, 0
WD_62:
    v_add_u32 v14, 16384, v12
    v_add_u32 v15, 77824, v12
    v_add_u32 v7, s64, v12
    ds_read_b128 v[16:19], v14 offset:0
    ds_read_b128 v[20:23], v14 offset:12288
    ds_read_b128 v[24:27], v14 offset:24576
    ds_read_b128 v[28:31], v14 offset:36864
    ds_read_b128 v[32:35], v14 offset:49152
    ds_read_b128 v[36:39], v15 offset:0
    ds_read_b128 v[40:43], v15 offset:12288
    ds_read_b128 v[44:47], v15 offset:24576
    ds_read_b128 v[48:51], v15 offset:36864
    ds_read_b128 v[52:55], v15 offset:49152
    s_waitcnt lgkmcnt(0)
    v_pk_add_f32 v[16:17], v[16:17], v[20:21]
    v_pk_add_f32 v[18:19], v[18:19], v[22:23]
    v_pk_add_f32 v[16:17], v[16:17], v[24:25]
    v_pk_add_f32 v[18:19], v[18:19], v[26:27]
    v_pk_add_f32 v[16:17], v[16:17], v[28:29]
    v_pk_add_f32 v[18:19], v[18:19], v[30:31]
    v_pk_add_f32 v[16:17], v[16:17], v[32:33]
    v_pk_add_f32 v[18:19], v[18:19], v[34:35]
    v_pk_add_f32 v[16:17], v[16:17], v[36:37]
    v_pk_add_f32 v[18:19], v[18:19], v[38:39]
    v_pk_add_f32 v[16:17], v[16:17], v[40:41]
    v_pk_add_f32 v[18:19], v[18:19], v[42:43]
    v_pk_add_f32 v[16:17], v[16:17], v[44:45]
    v_pk_add_f32 v[18:19], v[18:19], v[46:47]
    v_pk_add_f32 v[16:17], v[16:17], v[48:49]
    v_pk_add_f32 v[18:19], v[18:19], v[50:51]
    v_pk_add_f32 v[16:17], v[16:17], v[52:53]
    v_pk_add_f32 v[18:19], v[18:19], v[54:55]
    ds_write_b128 v7, v[16:19]
L_e1:
    v_bfe_u32 v7, v0, 0, 5
    v_lshlrev_b32 v14, 4, v7
    v_bfe_u32 v7, v0, 5, 1
    v_lshl_add_u32 v14, v7, 10, v14
    v_lshl_add_u32 v15, v7, 31, v14
    s_sub_u32 s84, s3, 10
    s_mul_i32 s81, s84, 5120
    s_add_u32 s81, s81, 302848
    s_add_u32 s82, s81, 4096
    s_mov_b32 s88, 0x00110011
    s_mov_b32 s89, 0x11001100
    s_mov_b32 s90, 0x00f0000f
    s_mov_b32 s91, 0xf0000f00
    v_mov_b32 v8, 0x3acccccd
    v_mov_b32 v9, 0x35a7c5ac
    v_cndmask_b32 v8, -v8, v8, s[90:91]
    v_cndmask_b32 v9, 0, v9, s[90:91]
    v_cndmask_b32 v10, 8, 0, s[90:91]
    v_mov_b32 v36, 0x3f803f80
    v_mov_b32 v37, 0x3f803f80
    v_mov_b32 v38, 0x3f803f80
    v_mov_b32 v39, 0x3f803f80
    v_mov_b64 v[40:41], 0
    v_mov_b64 v[44:45], 0
    v_mov_b64 v[48:49], 0
    v_mov_b64 v[52:53], 0
    v_mov_b64 v[56:57], 0
    v_mov_b64 v[60:61], 0
    v_mov_b64 v[64:65], 0
    v_mov_b64 v[68:69], 0
    v_bfe_u32 v7, v0, 5, 1
    v_lshlrev_b32 v12, 7, v7
    v_bfe_u32 v7, v0, 2, 1
    v_lshl_add_u32 v12, v7, 6, v12
    v_bfe_u32 v7, v0, 1, 1
    v_lshl_add_u32 v12, v7, 5, v12
    v_bfe_u32 v7, v0, 3, 2
    v_lshl_add_u32 v12, v7, 3, v12
    v_bfe_u32 v7, v0, 0, 1
    v_lshl_add_u32 v12, v7, 2, v12
    s_mul_i32 s83, s53, 1408
    s_lshl_b32 s84, s68, 7
    s_add_u32 s83, s83, s84
    s_add_u32 s83, s83, 312448
    s_mov_b32 s93, 0xbdd2d3e8
    s_waitcnt vmcnt(6)
    ds_read_b64_tr_b16 v[140:141], v2 offset:2048
    ds_read_b64_tr_b16 v[148:149], v3 offset:2048
    ds_read_b64_tr_b16 v[156:157], v4 offset:2048
    ds_read_b64_tr_b16 v[164:165], v5 offset:2048
    s_waitcnt vmcnt(4)
    ds_read_b64_tr_b16 v[78:79], v2 offset:4096
    ds_read_b64_tr_b16 v[86:87], v3 offset:4096
    ds_read_b64_tr_b16 v[94:95], v4 offset:4096
    ds_read_b64_tr_b16 v[102:103], v5 offset:4096
    s_waitcnt vmcnt(2)
    ds_read_b64_tr_b16 v[110:111], v2 offset:6144
    ds_read_b64_tr_b16 v[118:119], v3 offset:6144
    ds_read_b64_tr_b16 v[126:127], v4 offset:6144
    ds_read_b64_tr_b16 v[134:135], v5 offset:6144
    s_waitcnt vmcnt(0)
    ds_read_b64_tr_b16 v[142:143], v2 offset:8192
    ds_read_b64_tr_b16 v[150:151], v3 offset:8192
    ds_read_b64_tr_b16 v[158:159], v4 offset:8192
    ds_read_b64_tr_b16 v[166:167], v5 offset:8192
    s_setprio 2
    v_lshlrev_b32 v3, 2, v12
    v_add_u32 v3, 151552, v3
    v_lshlrev_b32 v12, 1, v12
    v_cmp_gt_u32 vcc, 16, v0
    v_lshlrev_b32 v2, 3, v0
    v_bfrev_b32 v7, 1
    v_cndmask_b32 v2, v7, v2, vcc
    v_mov_b32 v5, 0xc0135761
    s_mov_b32 s56, s26
    s_mov_b32 s57, s27
    s_mov_b32 s58, 1280
    s_mov_b32 s59, 0x20000
    v_lshlrev_b32 v7, 5, v0
    buffer_load_dword v4, v7, s[56:59], 0 offen
    buffer_load_dword v4, v2, s[32:35], s83 offen offset:128 sc1
    buffer_load_dword v4, v2, s[32:35], s83 offen offset:256 sc1
    buffer_load_dword v4, v2, s[32:35], s83 offen offset:0 sc1
    s_waitcnt lgkmcnt(0)
    s_barrier
    s_mov_b64 vcc, -1
S_63:
    s_mov_b64 exec, vcc
    buffer_load_dwordx4 v[16:19], v14, s[32:35], s81 offen offset:0 sc1
    buffer_load_dwordx4 v[20:23], v14, s[32:35], s81 offen offset:2048 sc1
    buffer_load_dwordx4 v[24:27], v15, s[32:35], s82 offen offset:0 sc1
    s_sub_u32 s99, s99, 16
    s_cselect_b32 s99, 0, s99
    s_cselect_b64 exec, 0, -1
    s_waitcnt vmcnt(0)
    v_max3_u32 v7, v16, v17, v18
    v_max3_u32 v7, v19, v20, v7
    v_max3_u32 v7, v21, v22, v7
    v_max3_u32 v7, v23, v24, v7
    v_max3_u32 v7, v25, v26, v7
    v_max_u32 v7, v27, v7
    v_cmp_eq_u32 vcc, -1, v7
    s_mov_b64 exec, -1
    s_cbranch_vccnz S_63
    v_mfma_f32_16x16x32_bf16 v[28:31], v[16:19], v[16:19], 0
    v_mfma_f32_16x16x32_bf16 v[32:35], v[36:39], v[16:19], 0
    v_mfma_f32_16x16x32_bf16 v[28:31], v[20:23], v[20:23], v[28:31]
    v_mfma_f32_16x16x32_bf16 v[32:35], v[36:39], v[20:23], v[32:35]
    v_mfma_f32_16x16x32_bf16 v[28:31], v[24:27], v[24:27], v[28:31]
    v_mfma_f32_16x16x32_bf16 v[32:35], v[36:39], v[24:27], v[32:35]
    ds_read_b64 v[16:17], v6 offset:64
    ds_read_b64 v[20:21], v6 offset:64
    ds_read_b64 v[24:25], v6 offset:64
    s_nop 3
    v_add_f32 v11, v28, v29
    v_add_f32 v30, v30, v31
    ds_read_b64 v[28:29], v6 offset:64
    v_add_f32 v11, v11, v30
    v_cndmask_b32 v11, v32, v11, s[90:91]
    s_nop 1
    v_add_f32_dpp v11, v11, v11 quad_perm:[1,0,3,2] row_mask:0xf bank_mask:0xf
    s_nop 1
    v_add_f32_dpp v11, v11, v11 quad_perm:[2,3,0,1] row_mask:0xf bank_mask:0xf
    v_fma_f32 v11, v11, v8, v9
    s_mov_b64 exec, s[88:89]
    v_cvt_f64_f32 v[8:9], v11
    ds_add_f64 v10, v[8:9] offset:16
    s_mov_b64 exec, -1
L_s2:
    s_cmp_eq_u32 s73, 0
    s_cbranch_scc1 L_s2x
    s_cmp_lt_u32 s3, 10
    s_waitcnt lgkmcnt(0)
    s_barrier
    ds_read_b128 v[8:11], v6 offset:16
    ds_read2st64_b64 v[32:35], v12 offset0:5 offset1:6
    ds_read_b128 v[36:39], v3
    s_waitcnt lgkmcnt(2)
    v_fma_f64 v[8:9], -v[10:11], v[10:11], v[8:9]
    v_cvt_f32_f64 v10, v[10:11]
    v_cvt_f32_f64 v8, v[8:9]
    v_max_f32 v8, 0x3727c5ac, v8
    v_rsq_f32 v8, v8
    s_waitcnt lgkmcnt(1)
    v_cvt_f32_f64 v32, v[32:33]
    v_cvt_f32_f64 v33, v[34:35]
    s_waitcnt lgkmcnt(0)
    v_pk_fma_f32 v[32:33], v[36:37], v[10:11], v[32:33] op_sel_hi:[1,0,1]
    v_pk_fma_f32 v[32:33], v[32:33], v[8:9], v[38:39] op_sel_hi:[1,0,1]
    v_mul_f32 v10, v32, v32
    v_mul_f32 v11, v33, v32
    v_fma_f32 v10, v10, s93, v5
    v_mul_f32 v10, v10, v32
    v_exp_f32 v10, v10
    v_mov_b32_dpp v14, v11 quad_perm:[2,3,0,1] row_mask:0xf bank_mask:0xf
    v_add_f32 v10, 1.0, v10
    v_rcp_f32 v10, v10
    s_nop 0
    v_mul_f32 v9, v11, v10
    v_mul_f32_dpp v14, v10, v14 quad_perm:[2,3,0,1] row_mask:0xf bank_mask:0xf
    v_cvt_pk_bf16_f32 v8, v9, v14
    s_nop 1
    v_mov_b32_dpp v9, v8 row_ror:12 row_mask:0xf bank_mask:0xf
    v_mov_b32_dpp v10, v8 row_ror:8 row_mask:0xf bank_mask:0xf
    v_mov_b32_dpp v11, v8 row_ror:4 row_mask:0xf bank_mask:0xf
    s_nop 1
    v_smfmac_f32_16x16x64_bf16 v[40:43], v[8:11], v[104:111], v13
    v_smfmac_f32_16x16x64_bf16 v[44:47], v[8:11], v[112:119], v13
    s_nop 2
    v_smfmac_f32_16x16x64_bf16 v[48:51], v[8:11], v[120:127], v13
    s_nop 1
    s_nop 0
    v_add_f32 v104, v40, v41
    v_smfmac_f32_16x16x64_bf16 v[52:55], v[8:11], v[128:135], v13
    s_nop 0
    v_add_f32 v105, v44, v45
    v_cvt_pk_bf16_f32 v104, v104, v105
    v_smfmac_f32_16x16x64_bf16 v[56:59], v[8:11], v[136:143], v13
    s_nop 1
    v_add_f32 v106, v48, v49
    v_smfmac_f32_16x16x64_bf16 v[60:63], v[8:11], v[144:151], v13
    s_nop 0
    v_add_f32 v107, v52, v53
    v_cvt_pk_bf16_f32 v105, v106, v107
    v_smfmac_f32_16x16x64_bf16 v[64:67], v[8:11], v[152:159], v13
    s_nop 0
    buffer_store_dwordx2 v[104:105], v2, s[32:35], s83 offen offset:128
    v_add_f32 v108, v56, v57
    v_smfmac_f32_16x16x64_bf16 v[68:71], v[8:11], v[160:167], v13
    s_nop 0
    v_add_f32 v109, v60, v61
    v_cvt_pk_bf16_f32 v108, v108, v109
    s_cbranch_scc1 L_s2ea
    v_smfmac_f32_16x16x64_bf16 v[16:19], v[8:11], v[72:79], v13
    s_nop 1
    v_add_f32 v110, v64, v65
    v_smfmac_f32_16x16x64_bf16 v[20:23], v[8:11], v[80:87], v13
    s_nop 0
    v_add_f32 v111, v68, v69
    v_cvt_pk_bf16_f32 v109, v110, v111
    v_smfmac_f32_16x16x64_bf16 v[24:27], v[8:11], v[88:95], v13
    s_nop 0
    buffer_store_dwordx2 v[108:109], v2, s[32:35], s83 offen offset:256
    v_add_f32 v112, v16, v17
    v_smfmac_f32_16x16x64_bf16 v[28:31], v[8:11], v[96:103], v13
    s_nop 0
    v_add_f32 v113, v20, v21
    v_cvt_pk_bf16_f32 v112, v112, v113
    s_nop 0
    v_add_f32 v114, v24, v25
    s_nop 2
    v_add_f32 v115, v28, v29
    v_cvt_pk_bf16_f32 v113, v114, v115
    buffer_store_dwordx2 v[112:113], v2, s[32:35], s83 offen offset:0
    s_barrier
    s_endpgm
L_s2ea:
    v_add_f32 v110, v64, v65
    s_nop 2
    v_add_f32 v111, v68, v69
    v_cvt_pk_bf16_f32 v109, v110, v111
    buffer_store_dwordx2 v[108:109], v2, s[32:35], s83 offen offset:256
    s_barrier
    s_endpgm
L_s2x:
    s_cmp_lt_u32 s3, 10
    s_waitcnt lgkmcnt(0)
    s_barrier
    ds_read_b128 v[8:11], v6 offset:16
    ds_read2st64_b64 v[32:35], v12 offset0:5 offset1:6
    ds_read_b128 v[36:39], v3
    s_waitcnt lgkmcnt(2)
    v_fma_f64 v[8:9], -v[10:11], v[10:11], v[8:9]
    v_cvt_f32_f64 v10, v[10:11]
    v_cvt_f32_f64 v8, v[8:9]
    v_max_f32 v8, 0x3727c5ac, v8
    v_rsq_f32 v8, v8
    s_waitcnt lgkmcnt(1)
    v_cvt_f32_f64 v32, v[32:33]
    v_cvt_f32_f64 v33, v[34:35]
    s_waitcnt lgkmcnt(0)
    v_pk_fma_f32 v[32:33], v[36:37], v[10:11], v[32:33] op_sel_hi:[1,0,1]
    v_pk_fma_f32 v[32:33], v[32:33], v[8:9], v[38:39] op_sel_hi:[1,0,1]
    v_mul_f32 v10, v32, v32
    v_mul_f32 v11, v33, v32
    v_fma_f32 v10, v10, s93, v5
    v_mul_f32 v10, v10, v32
    v_exp_f32 v10, v10
    v_mov_b32_dpp v14, v11 quad_perm:[2,3,0,1] row_mask:0xf bank_mask:0xf
    v_add_f32 v10, 1.0, v10
    v_rcp_f32 v10, v10
    s_nop 0
    v_mul_f32 v9, v11, v10
    v_mul_f32_dpp v14, v10, v14 quad_perm:[2,3,0,1] row_mask:0xf bank_mask:0xf
    v_cvt_pk_bf16_f32 v8, v9, v14
    s_nop 1
    v_mov_b32_dpp v9, v8 row_ror:12 row_mask:0xf bank_mask:0xf
    v_mov_b32_dpp v10, v8 row_ror:8 row_mask:0xf bank_mask:0xf
    v_mov_b32_dpp v11, v8 row_ror:4 row_mask:0xf bank_mask:0xf
    s_nop 1
    v_smfmac_f32_16x16x64_bf16 v[40:43], v[8:11], v[104:111], v13
    v_smfmac_f32_16x16x64_bf16 v[44:47], v[8:11], v[112:119], v13
    s_nop 2
    v_smfmac_f32_16x16x64_bf16 v[48:51], v[8:11], v[120:127], v13
    s_nop 1
    s_nop 0
    v_add_f32 v104, v40, v41
    v_smfmac_f32_16x16x64_bf16 v[52:55], v[8:11], v[128:135], v13
    s_nop 0
    v_add_f32 v105, v44, v45
    v_cvt_pk_bf16_f32 v104, v104, v105
    v_smfmac_f32_16x16x64_bf16 v[56:59], v[8:11], v[136:143], v13
    s_nop 1
    v_add_f32 v106, v48, v49
    v_smfmac_f32_16x16x64_bf16 v[60:63], v[8:11], v[144:151], v13
    s_nop 0
    v_add_f32 v107, v52, v53
    v_cvt_pk_bf16_f32 v105, v106, v107
    v_smfmac_f32_16x16x64_bf16 v[64:67], v[8:11], v[152:159], v13
    s_nop 0
    buffer_store_dwordx2 v[104:105], v2, s[32:35], s83 offen offset:128 sc1
    v_add_f32 v108, v56, v57
    v_smfmac_f32_16x16x64_bf16 v[68:71], v[8:11], v[160:167], v13
    s_nop 0
    v_add_f32 v109, v60, v61
    v_cvt_pk_bf16_f32 v108, v108, v109
    s_cbranch_scc1 L_s2eb
    v_smfmac_f32_16x16x64_bf16 v[16:19], v[8:11], v[72:79], v13
    s_nop 1
    v_add_f32 v110, v64, v65
    v_smfmac_f32_16x16x64_bf16 v[20:23], v[8:11], v[80:87], v13
    s_nop 0
    v_add_f32 v111, v68, v69
    v_cvt_pk_bf16_f32 v109, v110, v111
    v_smfmac_f32_16x16x64_bf16 v[24:27], v[8:11], v[88:95], v13
    s_nop 0
    buffer_store_dwordx2 v[108:109], v2, s[32:35], s83 offen offset:256 sc1
    v_add_f32 v112, v16, v17
    v_smfmac_f32_16x16x64_bf16 v[28:31], v[8:11], v[96:103], v13
    s_nop 0
    v_add_f32 v113, v20, v21
    v_cvt_pk_bf16_f32 v112, v112, v113
    s_nop 0
    v_add_f32 v114, v24, v25
    s_nop 2
    v_add_f32 v115, v28, v29
    v_cvt_pk_bf16_f32 v113, v114, v115
    buffer_store_dwordx2 v[112:113], v2, s[32:35], s83 offen offset:0 sc1
    s_barrier
    s_endpgm
L_s2eb:
    v_add_f32 v110, v64, v65
    s_nop 2
    v_add_f32 v111, v68, v69
    v_cvt_pk_bf16_f32 v109, v110, v111
    buffer_store_dwordx2 v[108:109], v2, s[32:35], s83 offen offset:256 sc1
    s_barrier
    s_endpgm
L_sv0:
    s_setprio 3
    s_mov_b32 s32, s30
    s_mov_b32 s33, s31
    s_mov_b32 s34, 660736
    s_mov_b32 s35, 0x20000
    v_mov_b64 v[18:19], -1
    v_mov_b64 v[20:21], -1
    v_lshlrev_b32 v10, 4, v0
    v_lshlrev_b32 v23, 3, v0
    s_mul_i32 s83, s53, 1408
    s_add_u32 s83, s83, 312576
    v_bfe_u32 v7, v0, 0, 3
    v_lshlrev_b32 v22, 2, v7
    v_bfe_u32 v7, v0, 4, 1
    v_lshl_add_u32 v22, v7, 5, v22
    v_bfe_u32 v7, v0, 3, 1
    v_lshl_add_u32 v22, v7, 6, v22
    v_bfe_u32 v7, v0, 0, 2
    v_lshlrev_b32 v24, 2, v7
    v_bfe_u32 v7, v0, 2, 4
    v_lshl_add_u32 v24, v7, 6, v24
    s_lshl_b32 s60, s67, 7
    s_lshl_b32 s61, s67, 4
    v_add_u32 v22, s60, v22
    v_add_u32 v24, s61, v24
    v_cmp_gt_u32 vcc, 32, v0
    s_nop 1
    v_cndmask_b32 v22, v24, v22, vcc
    v_lshlrev_b32 v23, 2, v0
    buffer_store_dwordx4 v[18:21], v10, s[32:35], s83 offen sc1
    buffer_store_dword v18, v23, s[32:35], s83 offen offset:1024 sc1
    s_cmp_eq_u32 s66, 0
    s_cbranch_scc1 L_tc
    buffer_store_dword v18, v22, s[32:35], s75 offen sc1
    s_cmp_lt_u32 s67, 2
    s_cbranch_scc1 L_tc
    buffer_store_dword v18, v22, s[32:35], s75 offen offset:1024 sc1
L_tc:
    s_barrier
    s_lshl_b32 s84, s65, 8
    v_lshl_add_u32 v24, v0, 2, s84
    global_load_dword v34, v24, s[4:5]
    v_bfe_u32 v16, v0, 2, 1
    v_mul_u32_u24 v16, 1056, v16
    v_lshl_add_u32 v16, v14, 7, v16
    v_and_b32 v17, 3, v0
    v_lshl_add_u32 v16, v17, 3, v16
    v_add3_u32 v2, v16, v15, s64
    v_xor_b32 v3, 32, v2
    v_xor_b32 v4, 64, v2
    v_xor_b32 v5, 96, v2
    v_and_b32 v13, 1, v0
    v_cmp_eq_u32 vcc, 1, v13
    v_mov_b32 v13, 0x44444444
    v_mov_b32 v17, 0x4444eeee
    v_cndmask_b32 v13, v13, v17, vcc
    v_bfe_u32 v17, v0, 3, 1
    v_mul_u32_u24 v17, 0xaaaa, v17
    v_lshl_add_u32 v13, v17, 16, v13
    s_mov_b32 s32, s30
    s_mov_b32 s33, s31
    s_mov_b32 s34, 660736
    s_mov_b32 s35, 0x20000
    s_waitcnt lgkmcnt(0)
    s_mul_i32 s52, s52, 0x5bd1e9c5
    s_add_u32 s52, s52, 0x6a09e6b7
    s_getreg_b32 s73, hwreg(HW_REG_XCC_ID, 0, 4)
    v_mov_b32 v25, s52
    v_mov_b32 v24, s73
    s_lshl_b32 s84, s53, 3
    s_add_u32 s84, s84, 236544
    s_waitcnt vmcnt(0)
    s_mov_b64 exec, 1
    buffer_store_dwordx2 v[24:25], v6, s[32:35], s84 offen sc1
    s_mov_b64 exec, -1
    s_cmp_lt_u32 s53, 27
    s_cbranch_scc1 L_sv1
    s_setprio 0
    s_branch L_ls
L_svl:
    s_getreg_b32 s73, hwreg(HW_REG_XCC_ID, 0, 4)
    v_mov_b32 v10, v12
    v_mov_b32 v34, 0
    s_nop 0
    s_branch L_sv2
L_sv1:
W_65:
    ds_read_b32 v7, v6 offset:0
    s_waitcnt lgkmcnt(0)
    v_readfirstlane_b32 s98, v7
    s_cmp_ge_u32 s98, 4
    s_nop 2
    s_cbranch_scc1 WD_66
    s_sleep 1
    s_sub_u32 s99, s99, 1
    s_cbranch_scc0 W_65
    s_mov_b32 s99, 0
WD_66:
L_sv2:
    v_mul_u32_u24 v14, 7, v0
    v_min_u32 v14, 59, v14
    v_and_b32 v15, 1, v14
    v_mul_u32_u24 v15, 20480, v15
    v_lshrrev_b32 v14, 1, v14
    v_lshl_add_u32 v14, v14, 9, v15
    s_mov_b32 s84, 45560
    s_mov_b32 s94, 236544
    v_and_b32 v15, 31, v0
    v_lshlrev_b32 v15, 3, v15
P_67:
    buffer_load_dwordx2 v[16:17], v14, s[32:35], s84 offen sc1
    s_waitcnt vmcnt(0)
    v_cmp_ne_u32 vcc, s52, v17
    s_cmp_eq_u64 vcc, 0
    s_nop 2
    s_cbranch_scc1 PD_68
    s_sleep 8
    s_sub_u32 s99, s99, 16
    s_cbranch_scc0 P_67
    s_mov_b32 s99, 0
PD_68:
    s_mov_b32 s84, 50176
    s_mov_b32 s85, 54272
    s_mov_b32 s86, 58368
    s_mov_b32 s87, 70656
    s_mov_b32 s88, 74752
    s_mov_b32 s89, 78848
    s_lshl_b32 s90, s65, 10
    s_add_u32 s90, s90, 45056
    s_add_u32 s91, s90, 20480
    s_add_u32 s92, s90, 10240
    s_add_u32 s93, s90, 30720
    s_cmp_lt_u32 s53, 27
    s_cbranch_scc1 L_svh
P_69:
    buffer_load_dwordx4 v[16:19], v10, s[32:35], s90 offen sc1
    buffer_load_dwordx4 v[20:23], v10, s[32:35], s91 offen sc1
    buffer_load_dwordx4 v[24:27], v10, s[32:35], s92 offen sc1
    buffer_load_dwordx4 v[28:31], v10, s[32:35], s93 offen sc1
    buffer_load_dwordx2 v[32:33], v15, s[32:35], s94 offen sc1
    s_waitcnt vmcnt(0)
    v_cmp_ne_u32 vcc, s52, v17
    v_cmp_ne_u32 s[96:97], s52, v19
    s_or_b64 vcc, vcc, s[96:97]
    v_cmp_ne_u32 s[96:97], s52, v21
    s_or_b64 vcc, vcc, s[96:97]
    v_cmp_ne_u32 s[96:97], s52, v23
    s_or_b64 vcc, vcc, s[96:97]
    v_cmp_ne_u32 s[96:97], s52, v25
    s_or_b64 vcc, vcc, s[96:97]
    v_cmp_ne_u32 s[96:97], s52, v27
    s_or_b64 vcc, vcc, s[96:97]
    v_cmp_ne_u32 s[96:97], s52, v29
    s_or_b64 vcc, vcc, s[96:97]
    v_cmp_ne_u32 s[96:97], s52, v31
    s_or_b64 vcc, vcc, s[96:97]
    v_cmp_ne_u32 s[96:97], s52, v33
    s_or_b64 vcc, vcc, s[96:97]
    s_cmp_eq_u64 vcc, 0
    s_nop 1
    s_cbranch_scc1 PD_70
    s_sleep 2
    s_sub_u32 s99, s99, 16
    s_cbranch_scc0 P_69
    s_mov_b32 s99, 0
PD_70:
    s_branch L_svg
L_svh:
P_71:
    buffer_load_dwordx4 v[16:19], v10, s[32:35], s90 offen sc1
    buffer_load_dwordx4 v[20:23], v10, s[32:35], s91 offen sc1
    buffer_load_dwordx4 v[24:27], v10, s[32:35], s92 offen sc1
    buffer_load_dwordx4 v[28:31], v10, s[32:35], s93 offen sc1
    buffer_load_dwordx2 v[32:33], v15, s[32:35], s94 offen sc1
    buffer_load_dwordx4 v[40:43], v10, s[32:35], s84 offen offset:0 sc1
    buffer_load_dwordx4 v[44:47], v10, s[32:35], s84 offen offset:1024 sc1
    buffer_load_dwordx4 v[48:51], v10, s[32:35], s84 offen offset:2048 sc1
    buffer_load_dwordx4 v[52:55], v10, s[32:35], s84 offen offset:3072 sc1
    buffer_load_dwordx4 v[56:59], v10, s[32:35], s85 offen offset:0 sc1
    buffer_load_dwordx4 v[60:63], v10, s[32:35], s85 offen offset:1024 sc1
    buffer_load_dwordx4 v[64:67], v10, s[32:35], s85 offen offset:2048 sc1
    buffer_load_dwordx4 v[68:71], v10, s[32:35], s85 offen offset:3072 sc1
    buffer_load_dwordx4 v[72:75], v10, s[32:35], s86 offen offset:0 sc1
    buffer_load_dwordx4 v[76:79], v10, s[32:35], s86 offen offset:1024 sc1
    buffer_load_dwordx4 v[80:83], v10, s[32:35], s87 offen offset:0 sc1
    buffer_load_dwordx4 v[84:87], v10, s[32:35], s87 offen offset:1024 sc1
    buffer_load_dwordx4 v[88:91], v10, s[32:35], s87 offen offset:2048 sc1
    buffer_load_dwordx4 v[92:95], v10, s[32:35], s87 offen offset:3072 sc1
    buffer_load_dwordx4 v[96:99], v10, s[32:35], s88 offen offset:0 sc1
    buffer_load_dwordx4 v[100:103], v10, s[32:35], s88 offen offset:1024 sc1
    buffer_load_dwordx4 v[104:107], v10, s[32:35], s88 offen offset:2048 sc1
    buffer_load_dwordx4 v[108:111], v10, s[32:35], s88 offen offset:3072 sc1
    buffer_load_dwordx4 v[112:115], v10, s[32:35], s89 offen offset:0 sc1
    buffer_load_dwordx4 v[116:119], v10, s[32:35], s89 offen offset:1024 sc1
    s_waitcnt vmcnt(0)
    v_cmp_ne_u32 vcc, s52, v17
    v_cmp_ne_u32 s[96:97], s52, v19
    s_or_b64 vcc, vcc, s[96:97]
    v_cmp_ne_u32 s[96:97], s52, v21
    s_or_b64 vcc, vcc, s[96:97]
    v_cmp_ne_u32 s[96:97], s52, v23
    s_or_b64 vcc, vcc, s[96:97]
    v_cmp_ne_u32 s[96:97], s52, v25
    s_or_b64 vcc, vcc, s[96:97]
    v_cmp_ne_u32 s[96:97], s52, v27
    s_or_b64 vcc, vcc, s[96:97]
    v_cmp_ne_u32 s[96:97], s52, v29
    s_or_b64 vcc, vcc, s[96:97]
    v_cmp_ne_u32 s[96:97], s52, v31
    s_or_b64 vcc, vcc, s[96:97]
    v_cmp_ne_u32 s[96:97], s52, v33
    s_or_b64 vcc, vcc, s[96:97]
    v_cmp_ne_u32 s[96:97], s52, v41
    s_or_b64 vcc, vcc, s[96:97]
    v_cmp_ne_u32 s[96:97], s52, v43
    s_or_b64 vcc, vcc, s[96:97]
    v_cmp_ne_u32 s[96:97], s52, v45
    s_or_b64 vcc, vcc, s[96:97]
    v_cmp_ne_u32 s[96:97], s52, v47
    s_or_b64 vcc, vcc, s[96:97]
    v_cmp_ne_u32 s[96:97], s52, v49
    s_or_b64 vcc, vcc, s[96:97]
    v_cmp_ne_u32 s[96:97], s52, v51
    s_or_b64 vcc, vcc, s[96:97]
    v_cmp_ne_u32 s[96:97], s52, v53
    s_or_b64 vcc, vcc, s[96:97]
    v_cmp_ne_u32 s[96:97], s52, v55
    s_or_b64 vcc, vcc, s[96:97]
    v_cmp_ne_u32 s[96:97], s52, v57
    s_or_b64 vcc, vcc, s[96:97]
    v_cmp_ne_u32 s[96:97], s52, v59
    s_or_b64 vcc, vcc, s[96:97]
    v_cmp_ne_u32 s[96:97], s52, v61
    s_or_b64 vcc, vcc, s[96:97]
    v_cmp_ne_u32 s[96:97], s52, v63
    s_or_b64 vcc, vcc, s[96:97]
    v_cmp_ne_u32 s[96:97], s52, v65
    s_or_b64 vcc, vcc, s[96:97]
    v_cmp_ne_u32 s[96:97], s52, v67
    s_or_b64 vcc, vcc, s[96:97]
    v_cmp_ne_u32 s[96:97], s52, v69
    s_or_b64 vcc, vcc, s[96:97]
    v_cmp_ne_u32 s[96:97], s52, v71
    s_or_b64 vcc, vcc, s[96:97]
    v_cmp_ne_u32 s[96:97], s52, v73
    s_or_b64 vcc, vcc, s[96:97]
    v_cmp_ne_u32 s[96:97], s52, v75
    s_or_b64 vcc, vcc, s[96:97]
    v_cmp_ne_u32 s[96:97], s52, v77
    s_or_b64 vcc, vcc, s[96:97]
    v_cmp_ne_u32 s[96:97], s52, v79
    s_or_b64 vcc, vcc, s[96:97]
    v_cmp_ne_u32 s[96:97], s52, v81
    s_or_b64 vcc, vcc, s[96:97]
    v_cmp_ne_u32 s[96:97], s52, v83
    s_or_b64 vcc, vcc, s[96:97]
    v_cmp_ne_u32 s[96:97], s52, v85
    s_or_b64 vcc, vcc, s[96:97]
    v_cmp_ne_u32 s[96:97], s52, v87
    s_or_b64 vcc, vcc, s[96:97]
    v_cmp_ne_u32 s[96:97], s52, v89
    s_or_b64 vcc, vcc, s[96:97]
    v_cmp_ne_u32 s[96:97], s52, v91
    s_or_b64 vcc, vcc, s[96:97]
    v_cmp_ne_u32 s[96:97], s52, v93
    s_or_b64 vcc, vcc, s[96:97]
    v_cmp_ne_u32 s[96:97], s52, v95
    s_or_b64 vcc, vcc, s[96:97]
    v_cmp_ne_u32 s[96:97], s52, v97
    s_or_b64 vcc, vcc, s[96:97]
    v_cmp_ne_u32 s[96:97], s52, v99
    s_or_b64 vcc, vcc, s[96:97]
    v_cmp_ne_u32 s[96:97], s52, v101
    s_or_b64 vcc, vcc, s[96:97]
    v_cmp_ne_u32 s[96:97], s52, v103
    s_or_b64 vcc, vcc, s[96:97]
    v_cmp_ne_u32 s[96:97], s52, v105
    s_or_b64 vcc, vcc, s[96:97]
    v_cmp_ne_u32 s[96:97], s52, v107
    s_or_b64 vcc, vcc, s[96:97]
    v_cmp_ne_u32 s[96:97], s52, v109
    s_or_b64 vcc, vcc, s[96:97]
    v_cmp_ne_u32 s[96:97], s52, v111
    s_or_b64 vcc, vcc, s[96:97]
    v_cmp_ne_u32 s[96:97], s52, v113
    s_or_b64 vcc, vcc, s[96:97]
    v_cmp_ne_u32 s[96:97], s52, v115
    s_or_b64 vcc, vcc, s[96:97]
    v_cmp_ne_u32 s[96:97], s52, v117
    s_or_b64 vcc, vcc, s[96:97]
    v_cmp_ne_u32 s[96:97], s52, v119
    s_or_b64 vcc, vcc, s[96:97]
    s_cmp_eq_u64 vcc, 0
    s_nop 1
    s_cbranch_scc1 PD_72
    s_sleep 2
    s_sub_u32 s99, s99, 16
    s_cbranch_scc0 P_71
    s_mov_b32 s99, 0
PD_72:
    v_bfe_u32 v7, v0, 5, 1
    v_lshlrev_b32 v15, 8, v7
    v_bfe_u32 v7, v0, 4, 1
    v_lshl_add_u32 v15, v7, 5, v15
    v_bfe_u32 v7, v0, 0, 2
    v_lshl_add_u32 v15, v7, 3, v15
    v_bfe_u32 v7, v0, 3, 1
    v_lshl_add_u32 v15, v7, 2, v15
    v_bfe_u32 v7, v0, 2, 1
    v_lshl_add_u32 v15, v7, 1, v15
    v_add_f32 v40, v40, v80
    v_add_f32 v42, v42, v82
    v_add_f32 v44, v44, v84
    v_add_f32 v46, v46, v86
    v_add_f32 v48, v48, v88
    v_add_f32 v50, v50, v90
    v_add_f32 v52, v52, v92
    v_add_f32 v54, v54, v94
    v_add_f32 v56, v56, v96
    v_add_f32 v58, v58, v98
    v_add_f32 v60, v60, v100
    v_add_f32 v62, v62, v102
    v_add_f32 v64, v64, v104
    v_add_f32 v66, v66, v106
    v_add_f32 v68, v68, v108
    v_add_f32 v70, v70, v110
    v_add_f32 v72, v72, v112
    v_add_f32 v74, v74, v114
    v_add_f32 v76, v76, v116
    v_add_f32 v78, v78, v118
    v_cvt_pk_bf16_f32 v40, v40, v42
    v_cvt_pk_bf16_f32 v44, v44, v46
    v_cvt_pk_bf16_f32 v48, v48, v50
    v_cvt_pk_bf16_f32 v52, v52, v54
    v_cvt_pk_bf16_f32 v56, v56, v58
    v_cvt_pk_bf16_f32 v60, v60, v62
    v_cvt_pk_bf16_f32 v64, v64, v66
    v_cvt_pk_bf16_f32 v68, v68, v70
    v_cvt_pk_bf16_f32 v72, v72, v74
    v_cvt_pk_bf16_f32 v76, v76, v78
    v_and_b32 v61, 0xffff0000, v60
    v_lshlrev_b32 v60, 16, v60
    v_add_f32 v61, 1.0, v61
    v_add_f32 v60, 1.0, v60
    v_cvt_pk_bf16_f32 v60, v60, v61
    v_and_b32 v65, 0xffff0000, v64
    v_lshlrev_b32 v64, 16, v64
    v_add_f32 v65, 1.0, v65
    v_add_f32 v64, 1.0, v64
    v_cvt_pk_bf16_f32 v64, v64, v65
    v_and_b32 v69, 0xffff0000, v68
    v_lshlrev_b32 v68, 16, v68
    v_add_f32 v69, 1.0, v69
    v_add_f32 v68, 1.0, v68
    v_cvt_pk_bf16_f32 v68, v68, v69
    v_and_b32 v73, 0xffff0000, v72
    v_lshlrev_b32 v72, 16, v72
    v_add_f32 v73, 1.0, v73
    v_add_f32 v72, 1.0, v72
    v_cvt_pk_bf16_f32 v72, v72, v73
    v_and_b32 v77, 0xffff0000, v76
    v_lshlrev_b32 v76, 16, v76
    v_add_f32 v77, 1.0, v77
    v_add_f32 v76, 1.0, v76
    v_cvt_pk_bf16_f32 v76, v76, v77
    ds_write_b16 v15, v40 offset:8832
    ds_write_b16_d16_hi v15, v40 offset:8896
    ds_write_b16 v15, v44 offset:9344
    ds_write_b16_d16_hi v15, v44 offset:9408
    ds_write_b16 v15, v48 offset:9856
    ds_write_b16_d16_hi v15, v48 offset:9920
    ds_write_b16 v15, v52 offset:10368
    ds_write_b16_d16_hi v15, v52 offset:10432
    ds_write_b16 v15, v56 offset:10880
    ds_write_b16_d16_hi v15, v56 offset:10944
    ds_write_b16 v15, v60 offset:8704
    ds_write_b16_d16_hi v15, v60 offset:8768
    ds_write_b16 v15, v64 offset:9216
    ds_write_b16_d16_hi v15, v64 offset:9280
    ds_write_b16 v15, v68 offset:9728
    ds_write_b16_d16_hi v15, v68 offset:9792
    ds_write_b16 v15, v72 offset:10240
    ds_write_b16_d16_hi v15, v72 offset:10304
    ds_write_b16 v15, v76 offset:10752
    ds_write_b16_d16_hi v15, v76 offset:10816
L_svg:
    v_cmp_ne_u32 vcc, s73, v32
    s_cmp_eq_u64 vcc, 0
    s_cselect_b32 s73, 3, 1
    v_add_f32 v17, v16, v20
    v_add_f32 v21, v18, v22
    v_add_f32 v24, v24, v28
    v_add_f32 v26, v26, v30
    v_cvt_pk_bf16_f32 v21, v17, v21
    v_cvt_pk_bf16_f32 v26, v24, v26
    v_lshlrev_b32 v17, 16, v21
    v_lshlrev_b32 v24, 16, v26
    v_and_b32 v21, 0xffff0000, v21
    v_and_b32 v26, 0xffff0000, v26
    v_add_f32 v24, 1.0, v24
    v_add_f32 v26, 1.0, v26
    v_cvt_pk_bf16_f32 v26, v24, v26
    v_lshlrev_b32 v24, 16, v26
    v_and_b32 v26, 0xffff0000, v26
    v_bfe_u32 v7, v0, 5, 1
    v_lshlrev_b32 v15, 10, v7
    v_bfe_u32 v7, v0, 4, 1
    v_lshl_add_u32 v15, v7, 8, v15
    v_bfe_u32 v7, v0, 0, 2
    v_lshl_add_u32 v15, v7, 5, v15
    v_bfe_u32 v7, v0, 3, 1
    v_lshl_add_u32 v15, v7, 4, v15
    v_bfe_u32 v7, v0, 2, 1
    v_lshl_add_u32 v15, v7, 2, v15
    v_add_u32 v15, 6656, v15
    s_cmp_eq_u32 s67, 2
    s_cselect_b32 s84, -1, 0
    v_and_b32 v34, s84, v34
    v_lshlrev_b32 v19, 16, v34
    v_and_b32 v23, 0xffff0000, v34
    v_mul_f32 v16, v17, v24
    v_mul_f32 v18, v19, v24
    v_mul_f32 v20, v21, v26
    v_mul_f32 v22, v23, v26
    v_mov_b32 v8, s73
    ds_write2_b32 v15, v16, v18 offset0:0 offset1:2
    ds_write2_b32 v15, v17, v19 offset0:128 offset1:130
    ds_write2_b32 v15, v20, v22 offset0:32 offset1:34
    ds_write2_b32 v15, v21, v23 offset0:160 offset1:162
    s_mov_b64 exec, 1
    ds_add_u32 v6, v8 offset:4
    s_mov_b64 exec, -1
    s_waitcnt lgkmcnt(0)
    s_setprio 0
    s_cmp_lt_u32 s53, 27
    s_cbranch_scc1 L_e0
    s_branch L_lo
L_end:
    s_endpgm
L_codeend:
.section .rodata,"a"
.p2align 6
.amdhsa_kernel adaLN_cond__sliding_block_cached__geglu_ffn__decode_kernel
  .amdhsa_next_free_vgpr 168
  .amdhsa_next_free_sgpr 102
  .amdhsa_accum_offset 168
  .amdhsa_group_segment_fixed_size 0
  .amdhsa_kernarg_size 112
  .amdhsa_user_sgpr_count 2
  .amdhsa_user_sgpr_kernarg_segment_ptr 1
  .amdhsa_system_sgpr_workgroup_id_x 1
.end_amdhsa_kernel
```
